```python
import torch

def _softmax(x, axis=-1):
    return torch.softmax(x, dim=axis)
def _gelu(x):
    return torch.nn.functional.gelu(x, approximate="tanh")
def _silu(x):
    return torch.nn.functional.silu(x)
def _sigmoid(x):
    return torch.sigmoid(x)
def _layernorm(x, axis=-1, eps=1e-5):
    m = x.mean(dim=axis, keepdim=True)
    v = x.var(dim=axis, keepdim=True, unbiased=False)
    return (x - m) / torch.sqrt(v + eps)
def _scatter_add(tgt, idx, src, axis=0):
    return tgt.clone().index_add_(axis, idx, src)
def _segment_sum(src, seg, n):
    out = torch.zeros((n,) + src.shape[1:], dtype=src.dtype)
    return out.index_add_(0, seg, src)
def _pad(x, pw):
    flat = tuple(v for pair in reversed(pw) for v in pair)
    return torch.nn.functional.pad(x, flat)

kernel_name = 'sequential_preLN__mha_block_cached__mixer_token_mlp__decode'

def setup_inputs():

    _w = (lambda a: (lambda t: t.to(torch.bfloat16) if t.is_floating_point() else t)(torch.as_tensor(a)))
    def _A_setup():
        B, Sq, D = 4, 1, 448
        H, Sk, Dh = 16, 4096, 256
        return {
            "x": _w((lambda *s: torch.randn(*s, dtype=torch.bfloat16) * 0.05)(B, Sq, D)),
            "k_cache": _w((lambda *s: torch.randn(*s, dtype=torch.bfloat16) * 1.6)(B, H, Sk, Dh)),
            "v_cache": _w((lambda *s: torch.randn(*s, dtype=torch.bfloat16) * 0.4)(B, H, Sk, Dh)),
            "wq": _w((lambda *s: torch.randn(*s, dtype=torch.bfloat16) * 1.6)(D, H * Dh) * (D ** -0.5)),
            "wo": _w((lambda *s: torch.randn(*s, dtype=torch.bfloat16) * 0.4)(H * Dh, D) * ((H * Dh) ** -0.5)),
        }
    _A_in = _A_setup()

    def _B_setup():
        B, S, D, F = 4, 1, 448, 1792
        return {
            "x": _w((lambda *s: torch.randn(*s, dtype=torch.bfloat16) * 0.05)(B, S, D)),
            "w1": _w((lambda *s: torch.randn(*s, dtype=torch.bfloat16) * 1.6)(S, F) * (S ** -0.5)),
            "b1": _w((lambda *s: torch.randn(*s, dtype=torch.bfloat16) * 0.1)(F) * 0.02),
            "w2": _w((lambda *s: torch.randn(*s, dtype=torch.bfloat16) * 0.1)(F, S) * (F ** -0.5)),
            "b2": _w((lambda *s: torch.randn(*s, dtype=torch.bfloat16) * 0.1)(S) * 0.02),
        }
    _B_in = _B_setup()

    return {
        "A_x": _A_in["x"],
        "A_k_cache": _A_in["k_cache"],
        "A_v_cache": _A_in["v_cache"],
        "A_wq": _A_in["wq"],
        "A_wo": _A_in["wo"],
        "B_x": _B_in["x"],
        "B_w1": _B_in["w1"],
        "B_b1": _B_in["b1"],
        "B_w2": _B_in["w2"],
        "B_b2": _B_in["b2"],
    }

def reference(A_x, A_k_cache, A_v_cache, A_wq, A_wo, B_x, B_w1, B_b1, B_w2, B_b2):
    def _A_ref(x, k_cache, v_cache, wq, wo):
        B, Sq, D = x.shape
        H, Dh = 16, 256
        q = (lambda x, *d: x.permute(*d))((x @ wq).reshape(B, Sq, H, Dh), 0, 2, 1, 3)
        scores = torch.einsum("bhqd,bhkd->bhqk", q, k_cache) * (Dh ** -0.5)
        p = _softmax(scores, axis=-1)
        o = torch.einsum("bhqk,bhkd->bhqd", p, v_cache)
        return (lambda x, *d: x.permute(*d))(o, 0, 2, 1, 3).reshape(B, Sq, H * Dh) @ wo

    def _B_ref(x, w1, b1, w2, b2):
        B, S, D = x.shape
        h = _layernorm(x, axis=-1)
        u = torch.einsum("bsd,sf->bdf", h, w1) + b1
        u = _gelu(u)
        y = torch.einsum("bdf,fs->bds", u, w2) + b2
        return (lambda x, *d: x.permute(*d))(y, 0, 2, 1)

    x = A_x
    h = x + _A_ref(_layernorm(x, axis=-1), A_k_cache, A_v_cache, A_wq, A_wo)
    h2 = h + _B_ref(_layernorm(h, axis=-1), B_w1, B_b1, B_w2, B_b2)
    return h2
```

```asm
; @launch grid=(256,1,1) block=(512,1,1) lds=134144
.amdgcn_target "amdgcn-amd-amdhsa--gfx950"
.text
.globl sequential_preLN__mha_block_cached__mixer_token_mlp__decode_kernel
.p2align 8
.type sequential_preLN__mha_block_cached__mixer_token_mlp__decode_kernel,@function
sequential_preLN__mha_block_cached__mixer_token_mlp__decode_kernel:
    s_memrealtime s[64:65]
    s_cmp_ge_u32 s2, 256
    s_cbranch_scc1 L_abort
    s_load_dwordx16 s[16:31], s[0:1], 0
    s_load_dwordx8 s[32:39], s[0:1], 64
    s_load_dwordx2 s[40:41], s[0:1], 96
    v_lshrrev_b32 v11, 6, v0
    v_and_b32 v0, 63, v0
    v_readfirstlane_b32 s3, v11
    s_bfe_u32 s48, s2, 0x20001
    s_lshl_b32 s48, s48, 6
    s_lshr_b32 s49, s2, 3
    s_lshl_b32 s49, s49, 1
    s_or_b32 s48, s48, s49
    s_and_b32 s2, s2, 1
    s_or_b32 s2, s2, s48
    v_and_b32 v11, 15, v0
    v_lshrrev_b32 v12, 4, v0
    v_lshrrev_b32 v14, 2, v11
    v_and_b32 v15, 3, v0
    v_lshlrev_b32 v1, 9, v14
    v_lshl_add_u32 v1, v12, 6, v1
    v_lshl_add_u32 v1, v15, 4, v1
    v_add_u32 v2, 0x2000, v1
    s_bfe_u32 s46, s2, 0x10001
    s_xor_b32 s46, s46, s2
    s_lshl_b32 s46, s46, 19
    s_and_b32 s48, s3, 1
    s_lshl_b32 s48, s48, 12
    s_add_u32 s46, s46, s48
    s_mov_b32 s83, 0
    s_lshl_b32 s48, s3, 1
    s_and_b32 s48, s48, 12
    s_lshl_b32 s49, s83, 12
    s_sub_u32 s49, 0xb204, s49
    s_lshr_b32 s49, s49, s48
    s_and_b32 s50, s49, 7
    s_lshl_b32 s50, s50, 15
    s_add_u32 s46, s46, s50
    s_and_b32 s49, s49, 8
    s_lshl_b32 s49, s49, 16
    s_xor_b32 s46, s46, s49
    s_lshl_b32 s49, s83, 12
    s_add_u32 s49, s49, 0x1220
    s_lshl_b32 s50, s83, 8
    s_sub_u32 s50, 0x0120, s50
    s_bitcmp1_b32 s2, 0
    s_cselect_b32 s49, s49, s50
    s_lshr_b32 s100, s49, s48
    s_and_b32 s100, s100, 15
    s_mov_b32 s47, s46
    s_mov_b32 s6, 0x8000000
    s_mov_b32 s7, 0x20000
    s_mov_b32 s10, 0x8000000
    s_mov_b32 s11, 0x20000
    v_mov_b32 v20, 0
    v_mov_b32 v21, 0
    v_mov_b32 v22, 0
    v_mov_b32 v23, 0
    v_lshlrev_b32 v3, 9, v12
    v_lshl_add_u32 v3, v11, 4, v3
    v_add_u32 v4, 0x2000, v3
    s_bitcmp1_b32 s2, 0
    s_cselect_b32 s48, 0x80, 0
    s_cselect_b32 s49, 0, 0xf0
    s_or_b32 s48, s48, s49
    s_lshr_b32 s48, s48, s3
    s_bitcmp1_b32 s48, 0
    s_cbranch_scc1 L_side
    s_waitcnt lgkmcnt(0)
    s_mov_b32 s4, s18
    s_and_b32 s5, s19, 0xffff
    s_mov_b32 s8, s20
    s_and_b32 s9, s21, 0xffff
    s_cmp_ge_u32 s3, 2
    s_cbranch_scc1 L_nf
    s_add_u32 s55, s47, 0
    buffer_load_dwordx4 v[72:75], v1, s[4:7], s55 offen offset:0 nt
    buffer_load_dwordx4 v[76:79], v1, s[4:7], s55 offen offset:256 nt
    buffer_load_dwordx4 v[80:83], v1, s[4:7], s55 offen offset:2048 nt
    buffer_load_dwordx4 v[84:87], v1, s[4:7], s55 offen offset:2304 nt
    buffer_load_dwordx4 v[88:91], v2, s[4:7], s55 offen offset:0 nt
    buffer_load_dwordx4 v[92:95], v2, s[4:7], s55 offen offset:256 nt
    buffer_load_dwordx4 v[96:99], v2, s[4:7], s55 offen offset:2048 nt
    buffer_load_dwordx4 v[100:103], v2, s[4:7], s55 offen offset:2304 nt
    s_add_u32 s55, s47, 32768
    buffer_load_dwordx4 v[104:107], v1, s[4:7], s55 offen offset:0 nt
    buffer_load_dwordx4 v[108:111], v1, s[4:7], s55 offen offset:256 nt
L_nf:
    s_barrier
    s_bitcmp1_b32 s2, 0
    s_cbranch_scc1 L_b2
    s_barrier
L_b2:
    s_load_dword s42, s[40:41], 0
    s_load_dword s82, s[34:35], 0
    s_cmp_ge_u32 s3, 2
    s_cbranch_scc1 L_common
    s_bitcmp1_b32 s2, 0
    s_cbranch_scc0 L_g0e
    s_waitcnt vmcnt(13)
    buffer_load_dwordx4 v[112:115], v1, s[4:7], s55 offen offset:2048 nt
    s_waitcnt vmcnt(13)
    buffer_load_dwordx4 v[116:119], v1, s[4:7], s55 offen offset:2304 nt
    s_waitcnt vmcnt(13)
    buffer_load_dwordx4 v[120:123], v2, s[4:7], s55 offen offset:0 nt
    s_waitcnt vmcnt(13)
    buffer_load_dwordx4 v[124:127], v2, s[4:7], s55 offen offset:256 nt
    s_waitcnt vmcnt(13)
    buffer_load_dwordx4 v[128:131], v2, s[4:7], s55 offen offset:2048 nt
    s_waitcnt vmcnt(13)
    buffer_load_dwordx4 v[132:135], v2, s[4:7], s55 offen offset:2304 nt
    s_waitcnt vmcnt(13)
    s_add_u32 s55, s47, 65536
    buffer_load_dwordx4 v[136:139], v1, s[4:7], s55 offen offset:0 nt
    s_waitcnt vmcnt(13)
    buffer_load_dwordx4 v[140:143], v1, s[4:7], s55 offen offset:256 nt
    s_waitcnt vmcnt(13)
    buffer_load_dwordx4 v[144:147], v1, s[4:7], s55 offen offset:2048 nt
    s_waitcnt vmcnt(13)
    buffer_load_dwordx4 v[148:151], v1, s[4:7], s55 offen offset:2304 nt
    s_waitcnt vmcnt(13)
    buffer_load_dwordx4 v[152:155], v2, s[4:7], s55 offen offset:0 nt
    s_waitcnt vmcnt(13)
    buffer_load_dwordx4 v[156:159], v2, s[4:7], s55 offen offset:256 nt
    s_waitcnt vmcnt(13)
    buffer_load_dwordx4 v[160:163], v2, s[4:7], s55 offen offset:2048 nt
    s_waitcnt vmcnt(13)
    buffer_load_dwordx4 v[164:167], v2, s[4:7], s55 offen offset:2304 nt
    s_waitcnt vmcnt(13)
    s_add_u32 s55, s47, 98304
    buffer_load_dwordx4 v[168:171], v1, s[4:7], s55 offen offset:0 nt
    s_waitcnt vmcnt(13)
    buffer_load_dwordx4 v[172:175], v1, s[4:7], s55 offen offset:256 nt
    s_waitcnt vmcnt(13)
    buffer_load_dwordx4 v[176:179], v1, s[4:7], s55 offen offset:2048 nt
    s_waitcnt vmcnt(13)
    buffer_load_dwordx4 v[180:183], v1, s[4:7], s55 offen offset:2304 nt
    s_waitcnt vmcnt(13)
    buffer_load_dwordx4 v[184:187], v2, s[4:7], s55 offen offset:0 nt
    s_waitcnt vmcnt(13)
    buffer_load_dwordx4 v[188:191], v2, s[4:7], s55 offen offset:256 nt
    s_waitcnt vmcnt(13)
    buffer_load_dwordx4 v[192:195], v2, s[4:7], s55 offen offset:2048 nt
    s_waitcnt vmcnt(13)
    buffer_load_dwordx4 v[196:199], v2, s[4:7], s55 offen offset:2304 nt
    s_branch L_g0x
L_g0e:
    s_add_u32 s55, s47, 32768
    s_waitcnt vmcnt(9)
    buffer_load_dwordx4 v[112:115], v1, s[4:7], s55 offen offset:2048 nt
    s_waitcnt vmcnt(9)
    buffer_load_dwordx4 v[116:119], v1, s[4:7], s55 offen offset:2304 nt
    s_waitcnt vmcnt(9)
    buffer_load_dwordx4 v[120:123], v2, s[4:7], s55 offen offset:0 nt
    s_waitcnt vmcnt(9)
    buffer_load_dwordx4 v[124:127], v2, s[4:7], s55 offen offset:256 nt
    s_waitcnt vmcnt(9)
    buffer_load_dwordx4 v[128:131], v2, s[4:7], s55 offen offset:2048 nt
    s_waitcnt vmcnt(9)
    buffer_load_dwordx4 v[132:135], v2, s[4:7], s55 offen offset:2304 nt
    s_waitcnt vmcnt(9)
    s_add_u32 s55, s47, 65536
    buffer_load_dwordx4 v[136:139], v1, s[4:7], s55 offen offset:0 nt
    s_waitcnt vmcnt(9)
    buffer_load_dwordx4 v[140:143], v1, s[4:7], s55 offen offset:256 nt
    s_waitcnt vmcnt(9)
    buffer_load_dwordx4 v[144:147], v1, s[4:7], s55 offen offset:2048 nt
    s_waitcnt vmcnt(9)
    buffer_load_dwordx4 v[148:151], v1, s[4:7], s55 offen offset:2304 nt
    s_waitcnt vmcnt(9)
    buffer_load_dwordx4 v[152:155], v2, s[4:7], s55 offen offset:0 nt
    s_waitcnt vmcnt(9)
    buffer_load_dwordx4 v[156:159], v2, s[4:7], s55 offen offset:256 nt
    s_waitcnt vmcnt(9)
    buffer_load_dwordx4 v[160:163], v2, s[4:7], s55 offen offset:2048 nt
    s_waitcnt vmcnt(9)
    buffer_load_dwordx4 v[164:167], v2, s[4:7], s55 offen offset:2304 nt
    s_waitcnt vmcnt(9)
    s_add_u32 s55, s47, 98304
    buffer_load_dwordx4 v[168:171], v1, s[4:7], s55 offen offset:0 nt
    s_waitcnt vmcnt(9)
    buffer_load_dwordx4 v[172:175], v1, s[4:7], s55 offen offset:256 nt
    s_waitcnt vmcnt(9)
    buffer_load_dwordx4 v[176:179], v1, s[4:7], s55 offen offset:2048 nt
    s_waitcnt vmcnt(9)
    buffer_load_dwordx4 v[180:183], v1, s[4:7], s55 offen offset:2304 nt
    s_waitcnt vmcnt(9)
    buffer_load_dwordx4 v[184:187], v2, s[4:7], s55 offen offset:0 nt
    s_waitcnt vmcnt(9)
    buffer_load_dwordx4 v[188:191], v2, s[4:7], s55 offen offset:256 nt
    s_waitcnt vmcnt(9)
    buffer_load_dwordx4 v[192:195], v2, s[4:7], s55 offen offset:2048 nt
    s_waitcnt vmcnt(9)
    buffer_load_dwordx4 v[196:199], v2, s[4:7], s55 offen offset:2304 nt
L_g0x:
    s_and_b32 s48, s3, 1
    s_lshl_b32 s48, s48, 2
    v_mov_b32 v11, s48
    v_mov_b32 v12, 1
    s_waitcnt vmcnt(8)
    s_mov_b64 exec, 1
    ds_add_u32 v11, v12 offset:560
    s_mov_b64 exec, -1
    v_and_b32 v11, 15, v0
    v_lshrrev_b32 v12, 4, v0
    s_branch L_common
L_side:
    s_setprio 3
    s_and_b32 s48, s3, 3
    s_mul_i32 s48, s48, 896
    v_lshlrev_b32 v13, 4, v0
    v_add_u32 v13, s48, v13
    v_lshrrev_b32 v16, 2, v0
    v_lshlrev_b32 v16, 13, v16
    v_lshl_add_u32 v16, v15, 4, v16
    s_and_b32 s50, s2, 0xfe
    s_lshl_b32 s49, s50, 5
    s_cmp_eq_u32 s3, 7
    s_cselect_b32 s55, 14336, 0
    s_cselect_b32 s51, 1835008, 0
    s_addc_u32 s50, s50, 0
    s_add_u32 s49, s49, s51
    s_add_u32 s55, s55, 35840
    s_mov_b32 s58, 0x380000
    s_mov_b32 s59, 0x20000
    ds_write_b128 v20, v[20:23] offset:512
    ds_write_b128 v20, v[20:23] offset:528
    ds_write_b128 v20, v[20:23] offset:544
    ds_write_b64 v20, v[20:21] offset:560
    s_bitcmp1_b32 s2, 0
    s_waitcnt lgkmcnt(0)
    s_cbranch_scc1 L_side2
    s_mov_b32 exec_hi, 0x00ffffff
    global_load_dwordx4 v[32:35], v13, s[16:17]
    s_mov_b32 exec_hi, -1
    s_barrier
    s_add_u32 s48, s3, 1
    s_bitcmp1_b32 s48, 1
    s_cbranch_scc1 L_side2
    s_mov_b32 s56, s22
    s_and_b32 s57, s23, 0xffff
    s_mov_b32 s62, s49
    s_mov_b32 s63, s55
    v_mov_b32 v19, v16
    s_add_u32 m0, s63, 0
    s_nop 0
    buffer_load_dwordx4 v19, s[56:59], s62 offen nt lds
    s_add_u32 m0, s63, 1024
    s_add_u32 s62, s62, 131072
    buffer_load_dwordx4 v19, s[56:59], s62 offen nt lds
    s_add_u32 m0, s63, 2048
    s_add_u32 s62, s62, 131072
    buffer_load_dwordx4 v19, s[56:59], s62 offen nt lds
    s_add_u32 m0, s63, 3072
    s_add_u32 s62, s62, 131072
    buffer_load_dwordx4 v19, s[56:59], s62 offen nt lds
    s_add_u32 m0, s63, 4096
    s_add_u32 s62, s62, 131072
    buffer_load_dwordx4 v19, s[56:59], s62 offen nt lds
    s_add_u32 m0, s63, 5120
    s_add_u32 s62, s62, 131072
    buffer_load_dwordx4 v19, s[56:59], s62 offen nt lds
    s_add_u32 m0, s63, 6144
    s_add_u32 s62, s62, 131072
    buffer_load_dwordx4 v19, s[56:59], s62 offen nt lds
    s_add_u32 m0, s63, 7168
    s_add_u32 s62, s62, 131072
    buffer_load_dwordx4 v19, s[56:59], s62 offen nt lds
    s_add_u32 m0, s63, 8192
    s_add_u32 s62, s62, 131072
    buffer_load_dwordx4 v19, s[56:59], s62 offen nt lds
    s_add_u32 m0, s63, 9216
    s_add_u32 s62, s62, 131072
    buffer_load_dwordx4 v19, s[56:59], s62 offen nt lds
    s_add_u32 m0, s63, 10240
    s_add_u32 s62, s62, 131072
    buffer_load_dwordx4 v19, s[56:59], s62 offen nt lds
    s_add_u32 m0, s63, 11264
    s_add_u32 s62, s62, 131072
    buffer_load_dwordx4 v19, s[56:59], s62 offen nt lds
    s_add_u32 m0, s63, 12288
    s_add_u32 s62, s62, 131072
    buffer_load_dwordx4 v19, s[56:59], s62 offen nt lds
    s_add_u32 m0, s63, 13312
    s_add_u32 s62, s62, 131072
    buffer_load_dwordx4 v19, s[56:59], s62 offen nt lds
L_side2:
    s_barrier
L_side3:
    s_load_dword s42, s[40:41], 0
    s_load_dword s82, s[34:35], 0
    s_mov_b32 s4, s18
    s_and_b32 s5, s19, 0xffff
    s_mov_b32 s8, s20
    s_and_b32 s9, s21, 0xffff
L_common:
    s_mov_b32 s12, s40
    s_and_b32 s13, s41, 0xffff
    s_mov_b32 s14, 0x300000
    s_mov_b32 s15, 0x20000
    s_mov_b32 s101, 0xffffff00
    v_and_b32 v17, 1, v0
    v_lshlrev_b32 v17, 4, v17
    v_mov_b32 v18, 0xffff
    v_lshlrev_b32 v18, v17, v18
    v_bfe_u32 v17, v0, 1, 2
    v_cmp_eq_u32 vcc, 0, v17
    s_nop 1
    v_cndmask_b32 v5, 0, v18, vcc
    v_cmp_eq_u32 vcc, 1, v17
    s_nop 1
    v_cndmask_b32 v6, 0, v18, vcc
    v_cmp_eq_u32 vcc, 2, v17
    s_nop 1
    v_cndmask_b32 v7, 0, v18, vcc
    v_cmp_eq_u32 vcc, 3, v17
    s_nop 1
    v_cndmask_b32 v8, 0, v18, vcc
    s_lshr_b32 s43, s2, 6
    s_bfe_u32 s44, s2, 0x40002
    s_and_b32 s45, s2, 3
    s_lshl_b32 s54, s43, 1
    s_lshr_b32 s51, s45, 1
    s_add_u32 s54, s54, s51
    s_lshr_b32 s51, s44, 2
    s_cmp_eq_u32 s51, 1
    s_cselect_b32 s53, 2, 0
    s_cmp_lt_u32 s54, 7
    s_cselect_b32 s53, 1, s53
    s_bitcmp1_b32 s45, 0
    s_cselect_b32 s53, 0, s53
    s_waitcnt lgkmcnt(0)
    s_mul_i32 s42, s42, 0x9e3779b1
    s_add_u32 s42, s42, 0x7f4a7c15
    s_lshl_b32 s82, s82, 16
    v_bfe_u32 v200, s42, 0, 8
    v_bfe_u32 v201, s42, 8, 8
    v_bfe_u32 v202, s42, 16, 8
    v_bfe_u32 v203, s42, 24, 8
    s_cmp_lt_u32 s3, 2
    s_cbranch_scc1 L_stream2
    s_cmp_lt_u32 s3, 4
    s_cbranch_scc1 L_tfill
    s_bitcmp1_b32 s2, 0
    s_cbranch_scc0 L_even
    s_cmp_eq_u32 s3, 7
    s_cbranch_scc1 L_w5
    s_branch L_tfill
L_even:
    v_lshlrev_b32 v16, 3, v12
    v_add_u32 v16, v16, v14
    v_lshlrev_b32 v16, 6, v16
    v_lshl_add_u32 v16, v15, 3, v16
    s_and_b32 s48, s50, 1
    s_lshl_b32 s48, s48, 5
    v_add_u32 v16, s48, v16
    v_mul_u32_u24 v17, 896, v15
    v_lshl_add_u32 v17, v12, 4, v17
    v_lshlrev_b32 v18, 14, v11
    v_lshl_add_u32 v18, v12, 4, v18
    s_lshl_b32 s55, s50, 6
    s_add_u32 s55, s55, 0x90000
    s_mov_b32 exec_hi, 0x00ffffff
    s_waitcnt vmcnt(14)
    s_add_u32 s48, s3, 1
    s_bitcmp1_b32 s48, 1
    s_cbranch_scc0 L_ln0
    s_waitcnt vmcnt(0)
L_ln0:
    v_lshlrev_b32 v40, 16, v32
    v_and_b32 v41, 0xffff0000, v32
    v_lshlrev_b32 v42, 16, v33
    v_and_b32 v43, 0xffff0000, v33
    v_lshlrev_b32 v44, 16, v34
    v_and_b32 v45, 0xffff0000, v34
    v_lshlrev_b32 v46, 16, v35
    v_and_b32 v47, 0xffff0000, v35
    v_readfirstlane_b32 s60, v40
    s_nop 1
    v_pk_add_f32 v[24:25], v[40:41], s[60:61] op_sel_hi:[1,0] neg_lo:[0,1] neg_hi:[0,1]
    v_pk_add_f32 v[26:27], v[42:43], s[60:61] op_sel_hi:[1,0] neg_lo:[0,1] neg_hi:[0,1]
    v_pk_add_f32 v[28:29], v[44:45], s[60:61] op_sel_hi:[1,0] neg_lo:[0,1] neg_hi:[0,1]
    v_pk_add_f32 v[30:31], v[46:47], s[60:61] op_sel_hi:[1,0] neg_lo:[0,1] neg_hi:[0,1]
    v_pk_mul_f32 v[22:23], v[24:25], v[24:25]
    v_pk_add_f32 v[32:33], v[24:25], v[26:27]
    v_pk_fma_f32 v[22:23], v[26:27], v[26:27], v[22:23]
    v_pk_add_f32 v[34:35], v[28:29], v[30:31]
    v_pk_fma_f32 v[22:23], v[28:29], v[28:29], v[22:23]
    v_pk_add_f32 v[32:33], v[32:33], v[34:35]
    v_pk_fma_f32 v[22:23], v[30:31], v[30:31], v[22:23]
    v_add_f32 v20, v32, v33
    v_add_f32 v21, v22, v23
    s_mov_b32 exec_hi, -1
    v_add_f32_dpp v20, v20, v20 row_ror:8 row_mask:0xf bank_mask:0xf
    v_add_f32_dpp v21, v21, v21 row_ror:8 row_mask:0xf bank_mask:0xf
    s_nop 0
    v_add_f32_dpp v20, v20, v20 row_ror:4 row_mask:0xf bank_mask:0xf
    v_add_f32_dpp v21, v21, v21 row_ror:4 row_mask:0xf bank_mask:0xf
    s_nop 0
    v_add_f32_dpp v20, v20, v20 row_ror:2 row_mask:0xf bank_mask:0xf
    v_add_f32_dpp v21, v21, v21 row_ror:2 row_mask:0xf bank_mask:0xf
    s_nop 0
    v_add_f32_dpp v20, v20, v20 row_ror:1 row_mask:0xf bank_mask:0xf
    v_add_f32_dpp v21, v21, v21 row_ror:1 row_mask:0xf bank_mask:0xf
    v_mov_b32 v22, v20
    v_mov_b32 v23, v21
    s_nop 0
    v_permlane16_swap_b32 v20, v22
    v_permlane16_swap_b32 v21, v23
    v_pk_add_f32 v[20:21], v[20:21], v[22:23]
    v_mov_b32 v22, v20
    v_mov_b32 v23, v21
    s_nop 0
    v_permlane32_swap_b32 v20, v22
    v_permlane32_swap_b32 v21, v23
    v_pk_add_f32 v[20:21], v[20:21], v[22:23]
    v_mul_f32 v22, 0x3b124925, v20
    v_mul_f32 v23, 0x3b124925, v21
    v_mov_b32 v20, 0
    v_mov_b32 v21, 0
    s_mov_b32 exec_hi, 0x00ffffff
    v_fma_f32 v23, -v22, v22, v23
    v_add_f32 v22, s60, v22
    v_max_f32 v23, 0, v23
    v_cvt_pk_bf16_f32 v22, v23, v22
    v_lshlrev_b32 v23, 16, v22
    v_and_b32 v22, 0xffff0000, v22
    v_add_f32 v23, 0x3727c5ac, v23
    v_pk_add_f32 v[40:41], v[40:41], v[22:23] op_sel_hi:[1,0] neg_lo:[0,1] neg_hi:[0,1]
    v_pk_add_f32 v[42:43], v[42:43], v[22:23] op_sel_hi:[1,0] neg_lo:[0,1] neg_hi:[0,1]
    v_pk_add_f32 v[44:45], v[44:45], v[22:23] op_sel_hi:[1,0] neg_lo:[0,1] neg_hi:[0,1]
    v_pk_add_f32 v[46:47], v[46:47], v[22:23] op_sel_hi:[1,0] neg_lo:[0,1] neg_hi:[0,1]
    v_cvt_pk_bf16_f32 v23, v23, v23
    v_and_b32 v23, 0xffff0000, v23
    v_sqrt_f32 v23, v23
    v_cvt_pk_bf16_f32 v32, v40, v41
    v_cvt_pk_bf16_f32 v33, v42, v43
    v_cvt_pk_bf16_f32 v34, v44, v45
    v_cvt_pk_bf16_f32 v35, v46, v47
    v_cvt_pk_bf16_f32 v23, v23, v23
    v_and_b32 v23, 0xffff0000, v23
    v_rcp_f32 v23, v23
    v_lshlrev_b32 v40, 16, v32
    v_and_b32 v41, 0xffff0000, v32
    v_lshlrev_b32 v42, 16, v33
    v_and_b32 v43, 0xffff0000, v33
    v_lshlrev_b32 v44, 16, v34
    v_and_b32 v45, 0xffff0000, v34
    v_lshlrev_b32 v46, 16, v35
    v_and_b32 v47, 0xffff0000, v35
    v_pk_mul_f32 v[40:41], v[40:41], v[22:23] op_sel:[0,1] op_sel_hi:[1,1]
    v_pk_mul_f32 v[42:43], v[42:43], v[22:23] op_sel:[0,1] op_sel_hi:[1,1]
    v_pk_mul_f32 v[44:45], v[44:45], v[22:23] op_sel:[0,1] op_sel_hi:[1,1]
    v_pk_mul_f32 v[46:47], v[46:47], v[22:23] op_sel:[0,1] op_sel_hi:[1,1]
    v_cvt_pk_bf16_f32 v32, v40, v41
    v_cvt_pk_bf16_f32 v33, v42, v43
    v_cvt_pk_bf16_f32 v34, v44, v45
    v_cvt_pk_bf16_f32 v35, v46, v47
    ds_write_b128 v13, v[32:35] offset:10880
    s_mov_b32 exec_hi, -1
    v_mov_b32 v13, 0
    v_mov_b32 v14, 1
    s_waitcnt lgkmcnt(0)
    s_mov_b64 exec, 1
    ds_add_u32 v13, v14 offset:516
    s_mov_b64 exec, -1
    s_cmp_eq_u32 s3, 5
    s_cbranch_scc1 L_w5
    s_cmp_eq_u32 s3, 6
    s_cbranch_scc1 L_wload
    s_mov_b32 s52, 1048576
    v_mov_b32 v11, 0
L_lnw:
    ds_read_b32 v12, v11 offset:516
    s_waitcnt lgkmcnt(0)
    v_readfirstlane_b32 s48, v12
    s_nop 0
    s_cmp_ge_u32 s48, 4
    s_cbranch_scc1 L_lnw_ok
    s_sub_u32 s52, s52, 1
    s_cbranch_scc0 L_lnw
    s_endpgm
L_lnw_ok:
    ds_read_b128 v[128:131], v17 offset:10880
    ds_read_b128 v[132:135], v17 offset:10944
    ds_read_b128 v[136:139], v17 offset:11008
    ds_read_b128 v[140:143], v17 offset:11072
    ds_read_b128 v[144:147], v17 offset:11136
    ds_read_b128 v[148:151], v17 offset:11200
    ds_read_b128 v[152:155], v17 offset:11264
    ds_read_b128 v[156:159], v17 offset:11328
    ds_read_b128 v[160:163], v17 offset:11392
    ds_read_b128 v[164:167], v17 offset:11456
    ds_read_b128 v[168:171], v17 offset:11520
    ds_read_b128 v[172:175], v17 offset:11584
    ds_read_b128 v[176:179], v17 offset:11648
    ds_read_b128 v[180:183], v17 offset:11712
    s_waitcnt vmcnt(0)
    s_mov_b64 exec, 1
    ds_add_u32 v13, v14 offset:548
    s_mov_b64 exec, -1
    s_mov_b32 s52, 1048576
    v_mov_b32 v11, 0
L_wqw:
    ds_read_b32 v12, v11 offset:548
    s_waitcnt lgkmcnt(0)
    v_readfirstlane_b32 s48, v12
    s_nop 0
    s_cmp_ge_u32 s48, 2
    s_cbranch_scc1 L_wqw_ok
    s_sub_u32 s52, s52, 1
    s_cbranch_scc0 L_wqw
    s_endpgm
L_wqw_ok:
    v_mov_b32 v33, s42
    v_mov_b32 v35, s42
    ds_read_b64_tr_b16 v[72:73], v16 offset:35840
    ds_read_b64_tr_b16 v[74:75], v16 offset:36096
    ds_read_b64_tr_b16 v[76:77], v16 offset:37888
    ds_read_b64_tr_b16 v[78:79], v16 offset:38144
    ds_read_b64_tr_b16 v[80:81], v16 offset:39936
    ds_read_b64_tr_b16 v[82:83], v16 offset:40192
    ds_read_b64_tr_b16 v[84:85], v16 offset:41984
    ds_read_b64_tr_b16 v[86:87], v16 offset:42240
    ds_read_b64_tr_b16 v[88:89], v16 offset:44032
    ds_read_b64_tr_b16 v[90:91], v16 offset:44288
    ds_read_b64_tr_b16 v[92:93], v16 offset:46080
    ds_read_b64_tr_b16 v[94:95], v16 offset:46336
    ds_read_b64_tr_b16 v[96:97], v16 offset:48128
    ds_read_b64_tr_b16 v[98:99], v16 offset:48384
    s_waitcnt lgkmcnt(12)
    v_mfma_f32_16x16x32_bf16 v[20:23], v[72:75], v[128:131], 0
    ds_read_b64_tr_b16 v[100:101], v16 offset:50176
    ds_read_b64_tr_b16 v[102:103], v16 offset:50432
    s_waitcnt lgkmcnt(12)
    v_mfma_f32_16x16x32_bf16 v[24:27], v[76:79], v[132:135], 0
    ds_read_b64_tr_b16 v[104:105], v16 offset:52224
    ds_read_b64_tr_b16 v[106:107], v16 offset:52480
    s_waitcnt lgkmcnt(12)
    v_mfma_f32_16x16x32_bf16 v[20:23], v[80:83], v[136:139], v[20:23]
    ds_read_b64_tr_b16 v[108:109], v16 offset:54272
    ds_read_b64_tr_b16 v[110:111], v16 offset:54528
    s_waitcnt lgkmcnt(12)
    v_mfma_f32_16x16x32_bf16 v[24:27], v[84:87], v[140:143], v[24:27]
    ds_read_b64_tr_b16 v[112:113], v16 offset:56320
    ds_read_b64_tr_b16 v[114:115], v16 offset:56576
    s_waitcnt lgkmcnt(12)
    v_mfma_f32_16x16x32_bf16 v[20:23], v[88:91], v[144:147], v[20:23]
    ds_read_b64_tr_b16 v[116:117], v16 offset:58368
    ds_read_b64_tr_b16 v[118:119], v16 offset:58624
    s_waitcnt lgkmcnt(12)
    v_mfma_f32_16x16x32_bf16 v[24:27], v[92:95], v[148:151], v[24:27]
    ds_read_b64_tr_b16 v[120:121], v16 offset:60416
    ds_read_b64_tr_b16 v[122:123], v16 offset:60672
    s_waitcnt lgkmcnt(12)
    v_mfma_f32_16x16x32_bf16 v[20:23], v[96:99], v[152:155], v[20:23]
    ds_read_b64_tr_b16 v[124:125], v16 offset:62464
    ds_read_b64_tr_b16 v[126:127], v16 offset:62720
    s_waitcnt lgkmcnt(12)
    v_mfma_f32_16x16x32_bf16 v[24:27], v[100:103], v[156:159], v[24:27]
    s_waitcnt lgkmcnt(10)
    v_mfma_f32_16x16x32_bf16 v[20:23], v[104:107], v[160:163], v[20:23]
    s_waitcnt lgkmcnt(8)
    v_mfma_f32_16x16x32_bf16 v[24:27], v[108:111], v[164:167], v[24:27]
    s_waitcnt lgkmcnt(6)
    v_mfma_f32_16x16x32_bf16 v[20:23], v[112:115], v[168:171], v[20:23]
    s_waitcnt lgkmcnt(4)
    v_mfma_f32_16x16x32_bf16 v[24:27], v[116:119], v[172:175], v[24:27]
    s_waitcnt lgkmcnt(2)
    v_mfma_f32_16x16x32_bf16 v[20:23], v[120:123], v[176:179], v[20:23]
    s_waitcnt lgkmcnt(0)
    v_mfma_f32_16x16x32_bf16 v[24:27], v[124:127], v[180:183], v[24:27]
    s_mov_b32 exec_lo, 0x000f000f
    s_mov_b32 exec_hi, 0x000f000f
    s_nop 5
    v_pk_add_f32 v[20:21], v[20:21], v[24:25]
    v_pk_add_f32 v[22:23], v[22:23], v[26:27]
    v_cvt_pk_bf16_f32 v32, v20, v21
    v_cvt_pk_bf16_f32 v34, v22, v23
    buffer_store_dwordx4 v[32:35], v18, s[12:15], s55 offen sc1
    s_mov_b64 exec, -1
    s_branch L_table
L_w5:
    v_lshlrev_b32 v13, 4, v0
    v_lshlrev_b32 v16, 3, v0
    s_lshl_b32 s48, s2, 8
    s_and_b32 s48, s48, 0xfc00
    s_add_u32 s48, s48, 0x90000
    s_mov_b32 s52, 131072
    s_add_u32 s60, s40, s48
    s_addc_u32 s61, s41, 0
L_spoll:
    s_load_dword s84, s[60:61], 60 glc
    s_load_dword s85, s[60:61], 124 glc
    s_load_dword s86, s[60:61], 188 glc
    s_load_dword s87, s[60:61], 252 glc
    s_load_dword s88, s[60:61], 316 glc
    s_load_dword s89, s[60:61], 380 glc
    s_load_dword s90, s[60:61], 444 glc
    s_load_dword s91, s[60:61], 508 glc
    s_load_dword s92, s[60:61], 572 glc
    s_load_dword s93, s[60:61], 636 glc
    s_load_dword s94, s[60:61], 700 glc
    s_load_dword s95, s[60:61], 764 glc
    s_load_dword s96, s[60:61], 828 glc
    s_load_dword s97, s[60:61], 892 glc
    s_load_dword s98, s[60:61], 956 glc
    s_load_dword s99, s[60:61], 1020 glc
    s_waitcnt lgkmcnt(0)
    s_xor_b32 s84, s84, s42
    s_xor_b32 s85, s85, s42
    s_or_b32 s84, s84, s85
    s_xor_b32 s86, s86, s42
    s_or_b32 s84, s84, s86
    s_xor_b32 s87, s87, s42
    s_or_b32 s84, s84, s87
    s_xor_b32 s88, s88, s42
    s_or_b32 s84, s84, s88
    s_xor_b32 s89, s89, s42
    s_or_b32 s84, s84, s89
    s_xor_b32 s90, s90, s42
    s_or_b32 s84, s84, s90
    s_xor_b32 s91, s91, s42
    s_or_b32 s84, s84, s91
    s_xor_b32 s92, s92, s42
    s_or_b32 s84, s84, s92
    s_xor_b32 s93, s93, s42
    s_or_b32 s84, s84, s93
    s_xor_b32 s94, s94, s42
    s_or_b32 s84, s84, s94
    s_xor_b32 s95, s95, s42
    s_or_b32 s84, s84, s95
    s_xor_b32 s96, s96, s42
    s_or_b32 s84, s84, s96
    s_xor_b32 s97, s97, s42
    s_or_b32 s84, s84, s97
    s_xor_b32 s98, s98, s42
    s_or_b32 s84, s84, s98
    s_xor_b32 s99, s99, s42
    s_or_b32 s84, s84, s99
    s_cmp_eq_u32 s84, 0
    s_cbranch_scc1 L_qpoll
    s_sub_u32 s52, s52, 1
    s_cbranch_scc0 L_spoll
    s_endpgm
L_qpoll:
    buffer_load_dwordx4 v[32:35], v13, s[12:15], s48 offen sc1
    s_waitcnt vmcnt(0)
    v_xor_b32 v14, s42, v33
    v_bitop3_b32 v14, v35, s42, v14 bitop3:0xbe
    v_mov_b32 v33, v34
    v_cmp_ne_u32 vcc, 0, v14
    s_cbranch_vccz L_qok
    s_sub_u32 s52, s52, 1
    s_cbranch_scc0 L_qpoll
    s_endpgm
L_qok:
    ds_write_b64 v16, v[32:33] offset:0
    v_mov_b32 v13, 0
    v_mov_b32 v14, 1
    s_waitcnt lgkmcnt(0)
    ds_write_b32 v13, v14 offset:512
    s_bitcmp1_b32 s2, 0
    s_cbranch_scc0 L_table
    s_setprio 0
    s_branch L_tfill
L_wload:
    v_lshlrev_b32 v13, 4, v0
    s_mov_b32 s56, s28
    s_and_b32 s57, s29, 0xffff
    s_mov_b32 s58, 0xe00
    s_mov_b32 s59, 0x20000
    s_mov_b32 m0, 22912
    s_nop 0
    buffer_load_dwordx4 v13, s[56:59], 0 offen offset:0 lds
    s_mov_b32 m0, 22912
    s_nop 0
    buffer_load_dwordx4 v13, s[56:59], 0 offen offset:1024 lds
    s_mov_b32 m0, 22912
    s_nop 0
    buffer_load_dwordx4 v13, s[56:59], 0 offen offset:2048 lds
    s_mov_b32 m0, 22912
    s_nop 0
    buffer_load_dwordx4 v13, s[56:59], 0 offen offset:3072 lds
    s_mov_b32 s56, s30
    s_and_b32 s57, s31, 0xffff
    s_mov_b32 s58, 0xe00
    s_mov_b32 s59, 0x20000
    s_mov_b32 m0, 27008
    s_nop 0
    buffer_load_dwordx4 v13, s[56:59], 0 offen offset:0 lds
    s_mov_b32 m0, 27008
    s_nop 0
    buffer_load_dwordx4 v13, s[56:59], 0 offen offset:1024 lds
    s_mov_b32 m0, 27008
    s_nop 0
    buffer_load_dwordx4 v13, s[56:59], 0 offen offset:2048 lds
    s_mov_b32 m0, 27008
    s_nop 0
    buffer_load_dwordx4 v13, s[56:59], 0 offen offset:3072 lds
    s_mov_b32 s56, s32
    s_and_b32 s57, s33, 0xffff
    s_mov_b32 s58, 0xe00
    s_mov_b32 s59, 0x20000
    s_mov_b32 m0, 31104
    s_nop 0
    buffer_load_dwordx4 v13, s[56:59], 0 offen offset:0 lds
    s_mov_b32 m0, 31104
    s_nop 0
    buffer_load_dwordx4 v13, s[56:59], 0 offen offset:1024 lds
    s_mov_b32 m0, 31104
    s_nop 0
    buffer_load_dwordx4 v13, s[56:59], 0 offen offset:2048 lds
    s_mov_b32 m0, 31104
    s_nop 0
    buffer_load_dwordx4 v13, s[56:59], 0 offen offset:3072 lds
    v_mov_b32 v13, 0
    v_mov_b32 v14, 1
    s_waitcnt vmcnt(0)
    ds_write_b32 v13, v14 offset:520
L_table:
    s_setprio 0
    s_mov_b32 s52, 1048576
    v_mov_b32 v11, 0
L_ww:
    ds_read_b32 v12, v11 offset:520
    s_waitcnt lgkmcnt(0)
    v_readfirstlane_b32 s48, v12
    s_nop 0
    s_cmp_ge_u32 s48, 1
    s_cbranch_scc1 L_ww_ok
    s_sleep 4
    s_sub_u32 s52, s52, 1
    s_cbranch_scc0 L_ww
    s_endpgm
L_ww_ok:
    v_lshlrev_b32 v13, 3, v0
    ds_read_b64 v[142:143], v13 offset:22912
    ds_read_b64 v[156:157], v13 offset:27008
    ds_read_b64 v[128:129], v13 offset:31104
    ds_read_b64 v[144:145], v13 offset:23424
    ds_read_b64 v[158:159], v13 offset:27520
    ds_read_b64 v[130:131], v13 offset:31616
    ds_read_b64 v[146:147], v13 offset:23936
    ds_read_b64 v[160:161], v13 offset:28032
    ds_read_b64 v[132:133], v13 offset:32128
    ds_read_b64 v[148:149], v13 offset:24448
    ds_read_b64 v[162:163], v13 offset:28544
    ds_read_b64 v[134:135], v13 offset:32640
    ds_read_b64 v[150:151], v13 offset:24960
    ds_read_b64 v[164:165], v13 offset:29056
    ds_read_b64 v[136:137], v13 offset:33152
    ds_read_b64 v[152:153], v13 offset:25472
    ds_read_b64 v[166:167], v13 offset:29568
    ds_read_b64 v[138:139], v13 offset:33664
    ds_read_b64 v[154:155], v13 offset:25984
    ds_read_b64 v[168:169], v13 offset:30080
    ds_read_b64 v[140:141], v13 offset:34176
    v_mov_b32 v188, 0xbdd2d3e8
    v_mov_b32 v190, 0xc0135761
    v_mov_b32 v189, 0xbdd2d3e8
    v_mov_b32 v191, 0xc0135761
    s_waitcnt lgkmcnt(0)
    v_lshlrev_b32 v72, 16, v142
    v_and_b32 v73, 0xffff0000, v142
    v_lshlrev_b32 v74, 16, v143
    v_and_b32 v75, 0xffff0000, v143
    v_lshlrev_b32 v76, 16, v144
    v_and_b32 v77, 0xffff0000, v144
    v_lshlrev_b32 v78, 16, v145
    v_and_b32 v79, 0xffff0000, v145
    v_lshlrev_b32 v80, 16, v146
    v_and_b32 v81, 0xffff0000, v146
    v_lshlrev_b32 v82, 16, v147
    v_and_b32 v83, 0xffff0000, v147
    v_lshlrev_b32 v84, 16, v148
    v_and_b32 v85, 0xffff0000, v148
    v_lshlrev_b32 v86, 16, v149
    v_and_b32 v87, 0xffff0000, v149
    v_lshlrev_b32 v88, 16, v150
    v_and_b32 v89, 0xffff0000, v150
    v_lshlrev_b32 v90, 16, v151
    v_and_b32 v91, 0xffff0000, v151
    v_lshlrev_b32 v92, 16, v152
    v_and_b32 v93, 0xffff0000, v152
    v_lshlrev_b32 v94, 16, v153
    v_and_b32 v95, 0xffff0000, v153
    v_lshlrev_b32 v96, 16, v154
    v_and_b32 v97, 0xffff0000, v154
    v_lshlrev_b32 v98, 16, v155
    v_and_b32 v99, 0xffff0000, v155
    v_lshlrev_b32 v100, 16, v156
    v_and_b32 v101, 0xffff0000, v156
    v_lshlrev_b32 v102, 16, v157
    v_and_b32 v103, 0xffff0000, v157
    v_lshlrev_b32 v104, 16, v158
    v_and_b32 v105, 0xffff0000, v158
    v_lshlrev_b32 v106, 16, v159
    v_and_b32 v107, 0xffff0000, v159
    v_lshlrev_b32 v108, 16, v160
    v_and_b32 v109, 0xffff0000, v160
    v_lshlrev_b32 v110, 16, v161
    v_and_b32 v111, 0xffff0000, v161
    v_lshlrev_b32 v112, 16, v162
    v_and_b32 v113, 0xffff0000, v162
    v_lshlrev_b32 v114, 16, v163
    v_and_b32 v115, 0xffff0000, v163
    v_lshlrev_b32 v116, 16, v164
    v_and_b32 v117, 0xffff0000, v164
    v_lshlrev_b32 v118, 16, v165
    v_and_b32 v119, 0xffff0000, v165
    v_lshlrev_b32 v120, 16, v166
    v_and_b32 v121, 0xffff0000, v166
    v_lshlrev_b32 v122, 16, v167
    v_and_b32 v123, 0xffff0000, v167
    v_lshlrev_b32 v124, 16, v168
    v_and_b32 v125, 0xffff0000, v168
    v_lshlrev_b32 v126, 16, v169
    v_and_b32 v127, 0xffff0000, v169
    s_bfe_u32 s48, s2, 0x60001
    s_mul_i32 s48, s48, 48
    s_mul_i32 s49, s3, 12
    s_add_u32 s48, s48, s49
    s_add_u32 s48, s48, 13776
    s_lshr_b32 s49, s2, 7
    s_lshl_b32 s49, s49, 15
    s_or_b32 s48, s48, s49
    s_lshl_b32 s48, s48, 16
    s_mov_b32 s55, 0
L_tloop:
    s_call_b64 s[62:63], L_mlp
    v_readfirstlane_b32 s49, v13
    s_mov_b32 m0, s55
    s_nop 0
    v_writelane_b32 v18, s49, m0
    s_add_u32 s48, s48, 0x10000
    s_add_u32 s55, s55, 1
    s_cmp_lt_u32 s55, 12
    s_cbranch_scc1 L_tloop
    s_mul_i32 s48, s3, 48
    v_lshlrev_b32 v13, 2, v0
    v_add_u32 v15, s48, v13
    v_mov_b32 v16, 0
    v_mov_b32 v14, 1
    s_mov_b64 exec, 0xfff
    ds_write_b32 v15, v18 offset:22464
    s_mov_b64 exec, 1
    ds_add_rtn_u32 v14, v16, v14 offset:524
    s_waitcnt lgkmcnt(0)
    s_mov_b64 exec, -1
    v_readfirstlane_b32 s48, v14
    s_setprio 3
    s_cmp_lg_u32 s48, 3
    s_cbranch_scc1 L_tpub
    s_mov_b32 exec_hi, 0xffff
    ds_read_b32 v14, v13 offset:22656
    v_and_b32 v15, 1, v0
    v_lshlrev_b32 v15, 4, v15
    v_lshrrev_b32 v15, v15, s42
    v_and_b32 v15, 0xffff, v15
    s_lshr_b32 s48, s2, 1
    s_mul_i32 s48, s48, 192
    s_add_u32 s48, s48, 0x80000
    s_waitcnt lgkmcnt(0)
    v_or_b32 v14, v14, v15
    buffer_store_dword v14, v13, s[12:15], s48 offen sc1
    s_mov_b32 exec_hi, -1
L_tpub:
    s_branch L_tdone
    s_branch L_tdone
L_tdone:
    s_waitcnt vmcnt(0) lgkmcnt(0)
    s_setprio 0
    s_cmp_eq_u32 s100, 0
    s_cbranch_scc1 L_stream2
    s_lshl_b32 s48, s3, 2
    s_mov_b32 s52, 1048576
    v_mov_b32 v11, s48
L_pfw:
    ds_read_b32 v12, v11 offset:512
    s_waitcnt lgkmcnt(0)
    v_readfirstlane_b32 s48, v12
    s_nop 0
    s_cmp_ge_u32 s48, 1
    s_cbranch_scc1 L_pfw_ok
    s_sleep 4
    s_sub_u32 s52, s52, 1
    s_cbranch_scc0 L_pfw
    s_endpgm
L_pfw_ok:
    s_lshl_b32 s48, s3, 15
    s_add_u32 s48, s48, 0xffff0c00
    v_lshlrev_b32 v13, 4, v0
    v_add_u32 v13, s48, v13
    ds_read_b128 v[72:75], v13 offset:0
    ds_read_b128 v[76:79], v13 offset:1024
    ds_read_b128 v[80:83], v13 offset:2048
    ds_read_b128 v[84:87], v13 offset:3072
    ds_read_b128 v[88:91], v13 offset:4096
    ds_read_b128 v[92:95], v13 offset:5120
    ds_read_b128 v[96:99], v13 offset:6144
    ds_read_b128 v[100:103], v13 offset:7168
    ds_read_b128 v[104:107], v13 offset:8192
    ds_read_b128 v[108:111], v13 offset:9216
    ds_read_b128 v[112:115], v13 offset:10240
    ds_read_b128 v[116:119], v13 offset:11264
    ds_read_b128 v[120:123], v13 offset:12288
    ds_read_b128 v[124:127], v13 offset:13312
    ds_read_b128 v[128:131], v13 offset:14336
    ds_read_b128 v[132:135], v13 offset:15360
    s_branch L_stream2
L_tfill:
    s_bfe_u32 s48, s2, 0x50001
    s_cmp_ge_u32 s48, 4
    s_cbranch_scc1 L_cp1
    s_cmp_ge_u32 s3, 4
    s_cbranch_scc1 L_cp1
    s_lshl_b32 s48, s48, 1
    s_and_b32 s49, s3, 1
    s_add_u32 s48, s48, s49
    s_mul_i32 s48, s48, 2304
    s_getpc_b64 s[60:61]
L_cp0:
    s_add_u32 s60, s60, L_stream2-L_cp0
    s_addc_u32 s61, s61, 0
    s_add_u32 s60, s60, s48
    s_addc_u32 s61, s61, 0
    s_load_dword s84, s[60:61], 0
    s_load_dword s85, s[60:61], 128
    s_load_dword s86, s[60:61], 256
    s_load_dword s87, s[60:61], 384
    s_load_dword s88, s[60:61], 512
    s_load_dword s89, s[60:61], 640
    s_load_dword s90, s[60:61], 768
    s_load_dword s91, s[60:61], 896
    s_load_dword s92, s[60:61], 1024
    s_load_dword s93, s[60:61], 1152
    s_load_dword s94, s[60:61], 1280
    s_load_dword s95, s[60:61], 1408
    s_load_dword s96, s[60:61], 1536
    s_load_dword s97, s[60:61], 1664
    s_load_dword s98, s[60:61], 1792
    s_load_dword s99, s[60:61], 1920
    s_load_dword s84, s[60:61], 2048
    s_load_dword s85, s[60:61], 2176
L_cp1:
    s_lshr_b32 s49, s3, 1
    s_and_b32 s48, s3, 1
    s_lshl_b32 s48, s48, 2
    s_mov_b32 s52, 1048576
    v_mov_b32 v11, s48
L_tw1:
    ds_read_b32 v12, v11 offset:560
    s_waitcnt lgkmcnt(0)
    v_readfirstlane_b32 s48, v12
    s_nop 0
    s_cmp_ge_u32 s48, s49
    s_cbranch_scc1 L_tw1_ok
    s_sleep 2
    s_sub_u32 s52, s52, 1
    s_cbranch_scc0 L_tw1
    s_endpgm
L_tw1_ok:
    s_cmp_eq_u32 s100, 0
    s_cbranch_scc1 L_tf1
    buffer_load_dwordx4 v[72:75], v1, s[4:7], s47 offen offset:0 nt
    buffer_load_dwordx4 v[76:79], v1, s[4:7], s47 offen offset:256 nt
    buffer_load_dwordx4 v[80:83], v1, s[4:7], s47 offen offset:2048 nt
    buffer_load_dwordx4 v[84:87], v1, s[4:7], s47 offen offset:2304 nt
    buffer_load_dwordx4 v[88:91], v2, s[4:7], s47 offen offset:0 nt
    buffer_load_dwordx4 v[92:95], v2, s[4:7], s47 offen offset:256 nt
    buffer_load_dwordx4 v[96:99], v2, s[4:7], s47 offen offset:2048 nt
    buffer_load_dwordx4 v[100:103], v2, s[4:7], s47 offen offset:2304 nt
    buffer_load_dwordx4 v[104:107], v3, s[8:11], s47 offen offset:0 nt
    buffer_load_dwordx4 v[108:111], v3, s[8:11], s47 offen offset:256 nt
    s_waitcnt vmcnt(9)
    buffer_load_dwordx4 v[112:115], v3, s[8:11], s47 offen offset:2048 nt
    s_waitcnt vmcnt(9)
    buffer_load_dwordx4 v[116:119], v3, s[8:11], s47 offen offset:2304 nt
    s_waitcnt vmcnt(9)
    buffer_load_dwordx4 v[120:123], v4, s[8:11], s47 offen offset:0 nt
    s_waitcnt vmcnt(9)
    buffer_load_dwordx4 v[124:127], v4, s[8:11], s47 offen offset:256 nt
    s_waitcnt vmcnt(9)
    buffer_load_dwordx4 v[128:131], v4, s[8:11], s47 offen offset:2048 nt
    s_waitcnt vmcnt(9)
    buffer_load_dwordx4 v[132:135], v4, s[8:11], s47 offen offset:2304 nt
    s_cmp_eq_u32 s100, 1
    s_cbranch_scc1 L_tf1
    s_add_u32 s47, s46, 32768
    s_waitcnt vmcnt(9)
    buffer_load_dwordx4 v[136:139], v1, s[4:7], s47 offen offset:0 nt
    s_waitcnt vmcnt(9)
    buffer_load_dwordx4 v[140:143], v1, s[4:7], s47 offen offset:256 nt
    s_waitcnt vmcnt(9)
    buffer_load_dwordx4 v[144:147], v1, s[4:7], s47 offen offset:2048 nt
    s_waitcnt vmcnt(9)
    buffer_load_dwordx4 v[148:151], v1, s[4:7], s47 offen offset:2304 nt
    s_waitcnt vmcnt(9)
    buffer_load_dwordx4 v[152:155], v2, s[4:7], s47 offen offset:0 nt
    s_waitcnt vmcnt(9)
    buffer_load_dwordx4 v[156:159], v2, s[4:7], s47 offen offset:256 nt
    s_waitcnt vmcnt(9)
    buffer_load_dwordx4 v[160:163], v2, s[4:7], s47 offen offset:2048 nt
    s_waitcnt vmcnt(9)
    buffer_load_dwordx4 v[164:167], v2, s[4:7], s47 offen offset:2304 nt
    s_waitcnt vmcnt(9)
    buffer_load_dwordx4 v[168:171], v3, s[8:11], s47 offen offset:0 nt
    s_waitcnt vmcnt(9)
    buffer_load_dwordx4 v[172:175], v3, s[8:11], s47 offen offset:256 nt
    s_waitcnt vmcnt(9)
    buffer_load_dwordx4 v[176:179], v3, s[8:11], s47 offen offset:2048 nt
    s_waitcnt vmcnt(9)
    buffer_load_dwordx4 v[180:183], v3, s[8:11], s47 offen offset:2304 nt
    s_waitcnt vmcnt(9)
    buffer_load_dwordx4 v[184:187], v4, s[8:11], s47 offen offset:0 nt
    s_waitcnt vmcnt(9)
    buffer_load_dwordx4 v[188:191], v4, s[8:11], s47 offen offset:256 nt
    s_waitcnt vmcnt(9)
    buffer_load_dwordx4 v[192:195], v4, s[8:11], s47 offen offset:2048 nt
    s_waitcnt vmcnt(9)
    buffer_load_dwordx4 v[196:199], v4, s[8:11], s47 offen offset:2304 nt
L_tf1:
    s_bitcmp1_b32 s2, 0
    s_cbranch_scc0 L_tf2
    s_and_b32 s48, s3, 1
    s_lshl_b32 s48, s48, 2
    v_mov_b32 v11, s48
    v_mov_b32 v12, 1
    s_waitcnt vmcnt(8)
    s_mov_b64 exec, 1
    ds_add_u32 v11, v12 offset:560
    s_mov_b64 exec, -1
    s_branch L_stream2
L_tf2:
    s_lshl_b32 s49, s3, 15
    s_add_u32 s49, s49, 0xc00
    s_add_u32 s50, s46, 65536
    s_cmp_lg_u32 s83, 0
    s_cbranch_scc1 L_tf3
    s_add_u32 m0, s49, 0x0
    s_waitcnt vmcnt(9)
    buffer_load_dwordx4 v1, s[4:7], s50 offen offset:0 nt lds
    s_add_u32 m0, s49, 0x300
    s_waitcnt vmcnt(9)
    buffer_load_dwordx4 v1, s[4:7], s50 offen offset:256 nt lds
    s_add_u32 m0, s49, 0x0
    s_waitcnt vmcnt(9)
    buffer_load_dwordx4 v1, s[4:7], s50 offen offset:2048 nt lds
    s_add_u32 m0, s49, 0x300
    s_waitcnt vmcnt(9)
    buffer_load_dwordx4 v1, s[4:7], s50 offen offset:2304 nt lds
    s_add_u32 m0, s49, 0x1000
    s_waitcnt vmcnt(9)
    buffer_load_dwordx4 v2, s[4:7], s50 offen offset:0 nt lds
    s_add_u32 m0, s49, 0x1300
    s_waitcnt vmcnt(9)
    buffer_load_dwordx4 v2, s[4:7], s50 offen offset:256 nt lds
    s_add_u32 m0, s49, 0x1000
    s_waitcnt vmcnt(9)
    buffer_load_dwordx4 v2, s[4:7], s50 offen offset:2048 nt lds
    s_add_u32 m0, s49, 0x1300
    s_waitcnt vmcnt(9)
    buffer_load_dwordx4 v2, s[4:7], s50 offen offset:2304 nt lds
    s_add_u32 m0, s49, 0x2000
    s_waitcnt vmcnt(9)
    buffer_load_dwordx4 v3, s[8:11], s50 offen offset:0 nt lds
    s_add_u32 m0, s49, 0x2300
    s_waitcnt vmcnt(9)
    buffer_load_dwordx4 v3, s[8:11], s50 offen offset:256 nt lds
    s_add_u32 m0, s49, 0x2000
    s_waitcnt vmcnt(9)
    buffer_load_dwordx4 v3, s[8:11], s50 offen offset:2048 nt lds
    s_add_u32 m0, s49, 0x2300
    s_waitcnt vmcnt(9)
    buffer_load_dwordx4 v3, s[8:11], s50 offen offset:2304 nt lds
    s_add_u32 m0, s49, 0x3000
    s_waitcnt vmcnt(9)
    buffer_load_dwordx4 v4, s[8:11], s50 offen offset:0 nt lds
    s_add_u32 m0, s49, 0x3300
    s_waitcnt vmcnt(9)
    buffer_load_dwordx4 v4, s[8:11], s50 offen offset:256 nt lds
    s_add_u32 m0, s49, 0x3000
    s_waitcnt vmcnt(9)
    buffer_load_dwordx4 v4, s[8:11], s50 offen offset:2048 nt lds
    s_add_u32 m0, s49, 0x3300
    s_waitcnt vmcnt(9)
    buffer_load_dwordx4 v4, s[8:11], s50 offen offset:2304 nt lds
L_tf3:
    s_and_b32 s48, s3, 1
    s_lshl_b32 s48, s48, 2
    v_mov_b32 v11, s48
    v_mov_b32 v12, 3
    s_waitcnt vmcnt(8)
    s_mov_b64 exec, 1
    ds_add_u32 v11, v12 offset:560
    s_mov_b64 exec, -1
    s_lshl_b32 s48, s3, 2
    v_mov_b32 v11, s48
    s_waitcnt vmcnt(0)
    ds_write_b32 v11, v12 offset:520
    s_branch L_stream2
L_mlp:
    v_mov_b32 v13, 0
    v_mov_b32 v14, 0
    v_pk_mul_f32 v[170:171], v[72:73], s[48:49] op_sel_hi:[1,0]
    v_pk_mul_f32 v[172:173], v[74:75], s[48:49] op_sel_hi:[1,0]
    v_pk_mul_f32 v[174:175], v[76:77], s[48:49] op_sel_hi:[1,0]
    v_pk_mul_f32 v[176:177], v[78:79], s[48:49] op_sel_hi:[1,0]
    v_cvt_pk_bf16_f32 v142, v170, v171
    v_cvt_pk_bf16_f32 v143, v172, v173
    v_cvt_pk_bf16_f32 v144, v174, v175
    v_cvt_pk_bf16_f32 v145, v176, v177
    v_lshlrev_b32 v170, 16, v142
    v_and_b32 v171, 0xffff0000, v142
    v_lshlrev_b32 v172, 16, v143
    v_and_b32 v173, 0xffff0000, v143
    v_lshlrev_b32 v174, 16, v144
    v_and_b32 v175, 0xffff0000, v144
    v_lshlrev_b32 v176, 16, v145
    v_and_b32 v177, 0xffff0000, v145
    v_pk_add_f32 v[170:171], v[170:171], v[100:101]
    v_pk_add_f32 v[172:173], v[172:173], v[102:103]
    v_pk_add_f32 v[174:175], v[174:175], v[104:105]
    v_pk_add_f32 v[176:177], v[176:177], v[106:107]
    v_cvt_pk_bf16_f32 v142, v170, v171
    v_cvt_pk_bf16_f32 v143, v172, v173
    v_cvt_pk_bf16_f32 v144, v174, v175
    v_cvt_pk_bf16_f32 v145, v176, v177
    v_lshlrev_b32 v170, 16, v142
    v_and_b32 v171, 0xffff0000, v142
    v_lshlrev_b32 v172, 16, v143
    v_and_b32 v173, 0xffff0000, v143
    v_lshlrev_b32 v174, 16, v144
    v_and_b32 v175, 0xffff0000, v144
    v_lshlrev_b32 v176, 16, v145
    v_and_b32 v177, 0xffff0000, v145
    v_pk_mul_f32 v[178:179], v[170:171], v[170:171]
    v_pk_mul_f32 v[180:181], v[172:173], v[172:173]
    v_pk_mul_f32 v[182:183], v[174:175], v[174:175]
    v_pk_mul_f32 v[184:185], v[176:177], v[176:177]
    v_pk_fma_f32 v[178:179], v[178:179], v[188:189], v[190:191]
    v_pk_fma_f32 v[180:181], v[180:181], v[188:189], v[190:191]
    v_pk_fma_f32 v[182:183], v[182:183], v[188:189], v[190:191]
    v_pk_fma_f32 v[184:185], v[184:185], v[188:189], v[190:191]
    v_pk_mul_f32 v[178:179], v[178:179], v[170:171]
    v_pk_mul_f32 v[180:181], v[180:181], v[172:173]
    v_pk_mul_f32 v[182:183], v[182:183], v[174:175]
    v_pk_mul_f32 v[184:185], v[184:185], v[176:177]
    v_exp_f32 v178, v178
    v_exp_f32 v179, v179
    v_exp_f32 v180, v180
    v_exp_f32 v181, v181
    v_exp_f32 v182, v182
    v_exp_f32 v183, v183
    v_exp_f32 v184, v184
    v_exp_f32 v185, v185
    v_pk_add_f32 v[178:179], v[178:179], 1.0 op_sel_hi:[1,0]
    v_pk_add_f32 v[180:181], v[180:181], 1.0 op_sel_hi:[1,0]
    v_pk_add_f32 v[182:183], v[182:183], 1.0 op_sel_hi:[1,0]
    v_pk_add_f32 v[184:185], v[184:185], 1.0 op_sel_hi:[1,0]
    v_rcp_f32 v178, v178
    v_rcp_f32 v179, v179
    v_rcp_f32 v180, v180
    v_rcp_f32 v181, v181
    v_rcp_f32 v182, v182
    v_rcp_f32 v183, v183
    v_rcp_f32 v184, v184
    v_rcp_f32 v185, v185
    v_pk_mul_f32 v[178:179], v[178:179], v[170:171]
    v_pk_mul_f32 v[180:181], v[180:181], v[172:173]
    v_pk_mul_f32 v[182:183], v[182:183], v[174:175]
    v_pk_mul_f32 v[184:185], v[184:185], v[176:177]
    v_cvt_pk_bf16_f32 v142, v178, v179
    v_cvt_pk_bf16_f32 v143, v180, v181
    v_cvt_pk_bf16_f32 v144, v182, v183
    v_cvt_pk_bf16_f32 v145, v184, v185
    v_dot2c_f32_bf16 v13, v142, v128
    v_dot2c_f32_bf16 v14, v143, v129
    v_dot2c_f32_bf16 v13, v144, v130
    v_dot2c_f32_bf16 v14, v145, v131
    v_pk_mul_f32 v[170:171], v[80:81], s[48:49] op_sel_hi:[1,0]
    v_pk_mul_f32 v[172:173], v[82:83], s[48:49] op_sel_hi:[1,0]
    v_pk_mul_f32 v[174:175], v[84:85], s[48:49] op_sel_hi:[1,0]
    v_pk_mul_f32 v[176:177], v[86:87], s[48:49] op_sel_hi:[1,0]
    v_cvt_pk_bf16_f32 v142, v170, v171
    v_cvt_pk_bf16_f32 v143, v172, v173
    v_cvt_pk_bf16_f32 v144, v174, v175
    v_cvt_pk_bf16_f32 v145, v176, v177
    v_lshlrev_b32 v170, 16, v142
    v_and_b32 v171, 0xffff0000, v142
    v_lshlrev_b32 v172, 16, v143
    v_and_b32 v173, 0xffff0000, v143
    v_lshlrev_b32 v174, 16, v144
    v_and_b32 v175, 0xffff0000, v144
    v_lshlrev_b32 v176, 16, v145
    v_and_b32 v177, 0xffff0000, v145
    v_pk_add_f32 v[170:171], v[170:171], v[108:109]
    v_pk_add_f32 v[172:173], v[172:173], v[110:111]
    v_pk_add_f32 v[174:175], v[174:175], v[112:113]
    v_pk_add_f32 v[176:177], v[176:177], v[114:115]
    v_cvt_pk_bf16_f32 v142, v170, v171
    v_cvt_pk_bf16_f32 v143, v172, v173
    v_cvt_pk_bf16_f32 v144, v174, v175
    v_cvt_pk_bf16_f32 v145, v176, v177
    v_lshlrev_b32 v170, 16, v142
    v_and_b32 v171, 0xffff0000, v142
    v_lshlrev_b32 v172, 16, v143
    v_and_b32 v173, 0xffff0000, v143
    v_lshlrev_b32 v174, 16, v144
    v_and_b32 v175, 0xffff0000, v144
    v_lshlrev_b32 v176, 16, v145
    v_and_b32 v177, 0xffff0000, v145
    v_pk_mul_f32 v[178:179], v[170:171], v[170:171]
    v_pk_mul_f32 v[180:181], v[172:173], v[172:173]
    v_pk_mul_f32 v[182:183], v[174:175], v[174:175]
    v_pk_mul_f32 v[184:185], v[176:177], v[176:177]
    v_pk_fma_f32 v[178:179], v[178:179], v[188:189], v[190:191]
    v_pk_fma_f32 v[180:181], v[180:181], v[188:189], v[190:191]
    v_pk_fma_f32 v[182:183], v[182:183], v[188:189], v[190:191]
    v_pk_fma_f32 v[184:185], v[184:185], v[188:189], v[190:191]
    v_pk_mul_f32 v[178:179], v[178:179], v[170:171]
    v_pk_mul_f32 v[180:181], v[180:181], v[172:173]
    v_pk_mul_f32 v[182:183], v[182:183], v[174:175]
    v_pk_mul_f32 v[184:185], v[184:185], v[176:177]
    v_exp_f32 v178, v178
    v_exp_f32 v179, v179
    v_exp_f32 v180, v180
    v_exp_f32 v181, v181
    v_exp_f32 v182, v182
    v_exp_f32 v183, v183
    v_exp_f32 v184, v184
    v_exp_f32 v185, v185
    v_pk_add_f32 v[178:179], v[178:179], 1.0 op_sel_hi:[1,0]
    v_pk_add_f32 v[180:181], v[180:181], 1.0 op_sel_hi:[1,0]
    v_pk_add_f32 v[182:183], v[182:183], 1.0 op_sel_hi:[1,0]
    v_pk_add_f32 v[184:185], v[184:185], 1.0 op_sel_hi:[1,0]
    v_rcp_f32 v178, v178
    v_rcp_f32 v179, v179
    v_rcp_f32 v180, v180
    v_rcp_f32 v181, v181
    v_rcp_f32 v182, v182
    v_rcp_f32 v183, v183
    v_rcp_f32 v184, v184
    v_rcp_f32 v185, v185
    v_pk_mul_f32 v[178:179], v[178:179], v[170:171]
    v_pk_mul_f32 v[180:181], v[180:181], v[172:173]
    v_pk_mul_f32 v[182:183], v[182:183], v[174:175]
    v_pk_mul_f32 v[184:185], v[184:185], v[176:177]
    v_cvt_pk_bf16_f32 v142, v178, v179
    v_cvt_pk_bf16_f32 v143, v180, v181
    v_cvt_pk_bf16_f32 v144, v182, v183
    v_cvt_pk_bf16_f32 v145, v184, v185
    v_dot2c_f32_bf16 v13, v142, v132
    v_dot2c_f32_bf16 v14, v143, v133
    v_dot2c_f32_bf16 v13, v144, v134
    v_dot2c_f32_bf16 v14, v145, v135
    v_pk_mul_f32 v[170:171], v[88:89], s[48:49] op_sel_hi:[1,0]
    v_pk_mul_f32 v[172:173], v[90:91], s[48:49] op_sel_hi:[1,0]
    v_pk_mul_f32 v[174:175], v[92:93], s[48:49] op_sel_hi:[1,0]
    v_pk_mul_f32 v[176:177], v[94:95], s[48:49] op_sel_hi:[1,0]
    v_cvt_pk_bf16_f32 v142, v170, v171
    v_cvt_pk_bf16_f32 v143, v172, v173
    v_cvt_pk_bf16_f32 v144, v174, v175
    v_cvt_pk_bf16_f32 v145, v176, v177
    v_lshlrev_b32 v170, 16, v142
    v_and_b32 v171, 0xffff0000, v142
    v_lshlrev_b32 v172, 16, v143
    v_and_b32 v173, 0xffff0000, v143
    v_lshlrev_b32 v174, 16, v144
    v_and_b32 v175, 0xffff0000, v144
    v_lshlrev_b32 v176, 16, v145
    v_and_b32 v177, 0xffff0000, v145
    v_pk_add_f32 v[170:171], v[170:171], v[116:117]
    v_pk_add_f32 v[172:173], v[172:173], v[118:119]
    v_pk_add_f32 v[174:175], v[174:175], v[120:121]
    v_pk_add_f32 v[176:177], v[176:177], v[122:123]
    v_cvt_pk_bf16_f32 v142, v170, v171
    v_cvt_pk_bf16_f32 v143, v172, v173
    v_cvt_pk_bf16_f32 v144, v174, v175
    v_cvt_pk_bf16_f32 v145, v176, v177
    v_lshlrev_b32 v170, 16, v142
    v_and_b32 v171, 0xffff0000, v142
    v_lshlrev_b32 v172, 16, v143
    v_and_b32 v173, 0xffff0000, v143
    v_lshlrev_b32 v174, 16, v144
    v_and_b32 v175, 0xffff0000, v144
    v_lshlrev_b32 v176, 16, v145
    v_and_b32 v177, 0xffff0000, v145
    v_pk_mul_f32 v[178:179], v[170:171], v[170:171]
    v_pk_mul_f32 v[180:181], v[172:173], v[172:173]
    v_pk_mul_f32 v[182:183], v[174:175], v[174:175]
    v_pk_mul_f32 v[184:185], v[176:177], v[176:177]
    v_pk_fma_f32 v[178:179], v[178:179], v[188:189], v[190:191]
    v_pk_fma_f32 v[180:181], v[180:181], v[188:189], v[190:191]
    v_pk_fma_f32 v[182:183], v[182:183], v[188:189], v[190:191]
    v_pk_fma_f32 v[184:185], v[184:185], v[188:189], v[190:191]
    v_pk_mul_f32 v[178:179], v[178:179], v[170:171]
    v_pk_mul_f32 v[180:181], v[180:181], v[172:173]
    v_pk_mul_f32 v[182:183], v[182:183], v[174:175]
    v_pk_mul_f32 v[184:185], v[184:185], v[176:177]
    v_exp_f32 v178, v178
    v_exp_f32 v179, v179
    v_exp_f32 v180, v180
    v_exp_f32 v181, v181
    v_exp_f32 v182, v182
    v_exp_f32 v183, v183
    v_exp_f32 v184, v184
    v_exp_f32 v185, v185
    v_pk_add_f32 v[178:179], v[178:179], 1.0 op_sel_hi:[1,0]
    v_pk_add_f32 v[180:181], v[180:181], 1.0 op_sel_hi:[1,0]
    v_pk_add_f32 v[182:183], v[182:183], 1.0 op_sel_hi:[1,0]
    v_pk_add_f32 v[184:185], v[184:185], 1.0 op_sel_hi:[1,0]
    v_rcp_f32 v178, v178
    v_rcp_f32 v179, v179
    v_rcp_f32 v180, v180
    v_rcp_f32 v181, v181
    v_rcp_f32 v182, v182
    v_rcp_f32 v183, v183
    v_rcp_f32 v184, v184
    v_rcp_f32 v185, v185
    v_pk_mul_f32 v[178:179], v[178:179], v[170:171]
    v_pk_mul_f32 v[180:181], v[180:181], v[172:173]
    v_pk_mul_f32 v[182:183], v[182:183], v[174:175]
    v_pk_mul_f32 v[184:185], v[184:185], v[176:177]
    v_cvt_pk_bf16_f32 v142, v178, v179
    v_cvt_pk_bf16_f32 v143, v180, v181
    v_cvt_pk_bf16_f32 v144, v182, v183
    v_cvt_pk_bf16_f32 v145, v184, v185
    v_dot2c_f32_bf16 v13, v142, v136
    v_dot2c_f32_bf16 v14, v143, v137
    v_dot2c_f32_bf16 v13, v144, v138
    v_dot2c_f32_bf16 v14, v145, v139
    v_pk_mul_f32 v[170:171], v[96:97], s[48:49] op_sel_hi:[1,0]
    v_pk_mul_f32 v[172:173], v[98:99], s[48:49] op_sel_hi:[1,0]
    v_cvt_pk_bf16_f32 v142, v170, v171
    v_cvt_pk_bf16_f32 v143, v172, v173
    v_lshlrev_b32 v170, 16, v142
    v_and_b32 v171, 0xffff0000, v142
    v_lshlrev_b32 v172, 16, v143
    v_and_b32 v173, 0xffff0000, v143
    v_pk_add_f32 v[170:171], v[170:171], v[124:125]
    v_pk_add_f32 v[172:173], v[172:173], v[126:127]
    v_cvt_pk_bf16_f32 v142, v170, v171
    v_cvt_pk_bf16_f32 v143, v172, v173
    v_lshlrev_b32 v170, 16, v142
    v_and_b32 v171, 0xffff0000, v142
    v_lshlrev_b32 v172, 16, v143
    v_and_b32 v173, 0xffff0000, v143
    v_pk_mul_f32 v[178:179], v[170:171], v[170:171]
    v_pk_mul_f32 v[180:181], v[172:173], v[172:173]
    v_pk_fma_f32 v[178:179], v[178:179], v[188:189], v[190:191]
    v_pk_fma_f32 v[180:181], v[180:181], v[188:189], v[190:191]
    v_pk_mul_f32 v[178:179], v[178:179], v[170:171]
    v_pk_mul_f32 v[180:181], v[180:181], v[172:173]
    v_exp_f32 v178, v178
    v_exp_f32 v179, v179
    v_exp_f32 v180, v180
    v_exp_f32 v181, v181
    v_pk_add_f32 v[178:179], v[178:179], 1.0 op_sel_hi:[1,0]
    v_pk_add_f32 v[180:181], v[180:181], 1.0 op_sel_hi:[1,0]
    v_rcp_f32 v178, v178
    v_rcp_f32 v179, v179
    v_rcp_f32 v180, v180
    v_rcp_f32 v181, v181
    v_pk_mul_f32 v[178:179], v[178:179], v[170:171]
    v_pk_mul_f32 v[180:181], v[180:181], v[172:173]
    v_cvt_pk_bf16_f32 v142, v178, v179
    v_cvt_pk_bf16_f32 v143, v180, v181
    v_dot2c_f32_bf16 v13, v142, v140
    v_dot2c_f32_bf16 v14, v143, v141
    s_nop 2
    v_add_f32 v13, v13, v14
    s_nop 1
    v_add_f32_dpp v13, v13, v13 row_ror:8 row_mask:0xf bank_mask:0xf
    s_nop 1
    v_add_f32_dpp v13, v13, v13 row_ror:4 row_mask:0xf bank_mask:0xf
    s_nop 1
    v_add_f32_dpp v13, v13, v13 row_ror:2 row_mask:0xf bank_mask:0xf
    s_nop 1
    v_add_f32_dpp v13, v13, v13 row_ror:1 row_mask:0xf bank_mask:0xf
    v_mov_b32 v14, v13
    s_nop 1
    v_permlane16_swap_b32 v13, v14
    v_add_f32 v13, v13, v14
    v_mov_b32 v14, v13
    s_nop 1
    v_permlane32_swap_b32 v13, v14
    v_add_f32 v13, v13, v14
    v_cvt_pk_bf16_f32 v13, v13, v13
    v_and_b32 v13, 0xffff0000, v13
    v_add_f32 v13, s82, v13
    v_cvt_pk_bf16_f32 v13, v13, v13
    v_and_b32 v13, 0xffff0000, v13
    s_nop 1
    s_setpc_b64 s[62:63]
L_stream2:
    v_mov_b32 v40, 0
    v_mov_b32 v41, 0
    v_mov_b32 v42, 0
    v_mov_b32 v43, 0
    v_mov_b32 v44, 0
    v_mov_b32 v45, 0
    v_mov_b32 v46, 0
    v_mov_b32 v47, 0
    v_mov_b32 v48, 0
    v_mov_b32 v49, 0
    v_mov_b32 v50, 0
    v_mov_b32 v51, 0
    v_mov_b32 v52, 0
    v_mov_b32 v53, 0
    v_mov_b32 v54, 0
    v_mov_b32 v55, 0
    v_mov_b32 v56, 0
    v_mov_b32 v57, 0
    v_mov_b32 v58, 0
    v_mov_b32 v59, 0
    v_mov_b32 v60, 0
    v_mov_b32 v61, 0
    v_mov_b32 v62, 0
    v_mov_b32 v63, 0
    v_mov_b32 v64, 0
    v_mov_b32 v65, 0
    v_mov_b32 v66, 0
    v_mov_b32 v67, 0
    v_mov_b32 v68, 0
    v_mov_b32 v69, 0
    v_mov_b32 v70, 0
    v_mov_b32 v71, 0
    v_mov_b32 v24, 0
    v_mov_b32 v25, 0
    v_mov_b32 v26, 0
    v_mov_b32 v27, 0
    v_mov_b32 v28, 0
    v_mov_b32 v29, 0
    v_mov_b32 v30, 0
    v_mov_b32 v31, 0
    v_mov_b32 v9, 0xff800000
    v_mov_b32 v10, 0
    v_and_b32 v18, 3, v0
    v_lshlrev_b32 v18, 4, v18
    v_lshrrev_b32 v19, 4, v0
    v_lshl_add_u32 v18, v19, 6, v18
    s_mov_b32 s52, 1048576
    v_mov_b32 v11, 0
L_qw:
    ds_read_b32 v12, v11 offset:512
    s_waitcnt lgkmcnt(0)
    v_readfirstlane_b32 s48, v12
    s_nop 0
    s_cmp_ge_u32 s48, 1
    s_cbranch_scc1 L_qw_ok
    s_sleep 1
    s_sub_u32 s52, s52, 1
    s_cbranch_scc0 L_qw
    s_endpgm
L_qw_ok:
    s_mov_b32 exec_lo, 0xf000f
    s_mov_b32 exec_hi, 0xf000f
    ds_read_b128 v[40:43], v18 offset:0
    ds_read_b128 v[44:47], v18 offset:256
    s_mov_b32 exec_lo, 0xf000f0
    s_mov_b32 exec_hi, 0xf000f0
    ds_read_b128 v[48:51], v18 offset:0
    ds_read_b128 v[52:55], v18 offset:256
    s_mov_b32 exec_lo, 0xf000f00
    s_mov_b32 exec_hi, 0xf000f00
    ds_read_b128 v[56:59], v18 offset:0
    ds_read_b128 v[60:63], v18 offset:256
    s_mov_b32 exec_lo, 0xf000f000
    s_mov_b32 exec_hi, 0xf000f000
    ds_read_b128 v[64:67], v18 offset:0
    ds_read_b128 v[68:71], v18 offset:256
    s_mov_b64 exec, -1
    s_mov_b32 s51, 0x3db8aa3b
    s_waitcnt lgkmcnt(0)
    s_cmp_lt_u32 s3, 2
    s_cbranch_scc1 L_main
    s_waitcnt vmcnt(0)
    s_cmp_eq_u32 s100, 0
    s_cbranch_scc1 L_mfin
    v_mfma_f32_16x16x32_bf16 v[20:23], v[72:75], v[40:43], 0
    v_mfma_f32_16x16x32_bf16 v[20:23], v[76:79], v[44:47], v[20:23]
    v_mfma_f32_16x16x32_bf16 v[20:23], v[80:83], v[48:51], v[20:23]
    v_mfma_f32_16x16x32_bf16 v[20:23], v[84:87], v[52:55], v[20:23]
    v_mfma_f32_16x16x32_bf16 v[20:23], v[88:91], v[56:59], v[20:23]
    v_mfma_f32_16x16x32_bf16 v[20:23], v[92:95], v[60:63], v[20:23]
    v_mfma_f32_16x16x32_bf16 v[20:23], v[96:99], v[64:67], v[20:23]
    v_mfma_f32_16x16x32_bf16 v[20:23], v[100:103], v[68:71], v[20:23]
    s_nop 7
    v_mov_b32_dpp v11, v20 quad_perm:[0,0,0,0] row_mask:0xf bank_mask:0xf
    v_mov_b32_dpp v12, v21 quad_perm:[1,1,1,1] row_mask:0xf bank_mask:0xf
    v_mov_b32_dpp v13, v22 quad_perm:[2,2,2,2] row_mask:0xf bank_mask:0xf
    v_mov_b32_dpp v14, v23 quad_perm:[3,3,3,3] row_mask:0xf bank_mask:0xf
    v_add_f32 v11, v11, v12
    v_add_f32 v13, v13, v14
    v_add_f32 v11, v11, v13
    v_cvt_pk_bf16_f32 v11, v11, v11
    v_and_b32 v11, 0xffff0000, v11
    v_mul_f32 v204, s51, v11
    v_mov_b32 v12, v204
    s_nop 1
    v_max_f32_dpp v12, v12, v12 row_ror:4 row_mask:0xf bank_mask:0xf
    s_nop 1
    v_max_f32_dpp v12, v12, v12 row_ror:8 row_mask:0xf bank_mask:0xf
    v_mov_b32 v13, v12
    s_nop 1
    v_permlane16_swap_b32 v12, v13
    v_max_f32 v12, v12, v13
    v_mov_b32 v13, v12
    s_nop 1
    v_permlane32_swap_b32 v12, v13
    v_max_f32 v12, v12, v13
    v_max_f32 v12, v12, v9
    v_sub_f32 v13, v9, v12
    v_sub_f32 v204, v204, v12
    v_exp_f32 v13, v13
    v_exp_f32 v204, v204
    v_mov_b32 v9, v12
    v_fma_f32 v10, v10, v13, v204
    v_pk_mul_f32 v[24:25], v[24:25], v[12:13] op_sel:[0,1] op_sel_hi:[1,1]
    v_pk_mul_f32 v[26:27], v[26:27], v[12:13] op_sel:[0,1] op_sel_hi:[1,1]
    v_pk_mul_f32 v[28:29], v[28:29], v[12:13] op_sel:[0,1] op_sel_hi:[1,1]
    v_pk_mul_f32 v[30:31], v[30:31], v[12:13] op_sel:[0,1] op_sel_hi:[1,1]
    v_cvt_pk_bf16_f32 v204, v204, v204
    s_nop 1
    v_and_b32_dpp v32, v204, v5 row_newbcast:0 row_mask:0xf bank_mask:0xf
    v_and_b32_dpp v33, v204, v6 row_newbcast:0 row_mask:0xf bank_mask:0xf
    v_and_b32_dpp v34, v204, v7 row_newbcast:0 row_mask:0xf bank_mask:0xf
    v_and_b32_dpp v35, v204, v8 row_newbcast:0 row_mask:0xf bank_mask:0xf
    s_nop 1
    v_mfma_f32_16x16x32_bf16 v[24:27], v[32:35], v[104:107], v[24:27]
    v_mfma_f32_16x16x32_bf16 v[28:31], v[32:35], v[108:111], v[28:31]
    v_and_b32_dpp v36, v204, v5 row_newbcast:4 row_mask:0xf bank_mask:0xf
    v_and_b32_dpp v37, v204, v6 row_newbcast:4 row_mask:0xf bank_mask:0xf
    v_and_b32_dpp v38, v204, v7 row_newbcast:4 row_mask:0xf bank_mask:0xf
    v_and_b32_dpp v39, v204, v8 row_newbcast:4 row_mask:0xf bank_mask:0xf
    s_nop 1
    v_mfma_f32_16x16x32_bf16 v[24:27], v[36:39], v[112:115], v[24:27]
    v_mfma_f32_16x16x32_bf16 v[28:31], v[36:39], v[116:119], v[28:31]
    v_and_b32_dpp v32, v204, v5 row_newbcast:8 row_mask:0xf bank_mask:0xf
    v_and_b32_dpp v33, v204, v6 row_newbcast:8 row_mask:0xf bank_mask:0xf
    v_and_b32_dpp v34, v204, v7 row_newbcast:8 row_mask:0xf bank_mask:0xf
    v_and_b32_dpp v35, v204, v8 row_newbcast:8 row_mask:0xf bank_mask:0xf
    s_nop 1
    v_mfma_f32_16x16x32_bf16 v[24:27], v[32:35], v[120:123], v[24:27]
    v_mfma_f32_16x16x32_bf16 v[28:31], v[32:35], v[124:127], v[28:31]
    v_and_b32_dpp v36, v204, v5 row_newbcast:12 row_mask:0xf bank_mask:0xf
    v_and_b32_dpp v37, v204, v6 row_newbcast:12 row_mask:0xf bank_mask:0xf
    v_and_b32_dpp v38, v204, v7 row_newbcast:12 row_mask:0xf bank_mask:0xf
    v_and_b32_dpp v39, v204, v8 row_newbcast:12 row_mask:0xf bank_mask:0xf
    s_nop 1
    v_mfma_f32_16x16x32_bf16 v[24:27], v[36:39], v[128:131], v[24:27]
    v_mfma_f32_16x16x32_bf16 v[28:31], v[36:39], v[132:135], v[28:31]
    s_cmp_eq_u32 s100, 1
    s_cbranch_scc1 L_mfin
    v_mfma_f32_16x16x32_bf16 v[20:23], v[136:139], v[40:43], 0
    v_mfma_f32_16x16x32_bf16 v[20:23], v[140:143], v[44:47], v[20:23]
    v_mfma_f32_16x16x32_bf16 v[20:23], v[144:147], v[48:51], v[20:23]
    v_mfma_f32_16x16x32_bf16 v[20:23], v[148:151], v[52:55], v[20:23]
    v_mfma_f32_16x16x32_bf16 v[20:23], v[152:155], v[56:59], v[20:23]
    v_mfma_f32_16x16x32_bf16 v[20:23], v[156:159], v[60:63], v[20:23]
    v_mfma_f32_16x16x32_bf16 v[20:23], v[160:163], v[64:67], v[20:23]
    v_mfma_f32_16x16x32_bf16 v[20:23], v[164:167], v[68:71], v[20:23]
    s_nop 7
    v_mov_b32_dpp v11, v20 quad_perm:[0,0,0,0] row_mask:0xf bank_mask:0xf
    v_mov_b32_dpp v12, v21 quad_perm:[1,1,1,1] row_mask:0xf bank_mask:0xf
    v_mov_b32_dpp v13, v22 quad_perm:[2,2,2,2] row_mask:0xf bank_mask:0xf
    v_mov_b32_dpp v14, v23 quad_perm:[3,3,3,3] row_mask:0xf bank_mask:0xf
    v_add_f32 v11, v11, v12
    v_add_f32 v13, v13, v14
    v_add_f32 v11, v11, v13
    v_cvt_pk_bf16_f32 v11, v11, v11
    v_and_b32 v11, 0xffff0000, v11
    v_mul_f32 v204, s51, v11
    v_mov_b32 v12, v204
    s_nop 1
    v_max_f32_dpp v12, v12, v12 row_ror:4 row_mask:0xf bank_mask:0xf
    s_nop 1
    v_max_f32_dpp v12, v12, v12 row_ror:8 row_mask:0xf bank_mask:0xf
    v_mov_b32 v13, v12
    s_nop 1
    v_permlane16_swap_b32 v12, v13
    v_max_f32 v12, v12, v13
    v_mov_b32 v13, v12
    s_nop 1
    v_permlane32_swap_b32 v12, v13
    v_max_f32 v12, v12, v13
    v_max_f32 v12, v12, v9
    v_sub_f32 v13, v9, v12
    v_sub_f32 v204, v204, v12
    v_exp_f32 v13, v13
    v_exp_f32 v204, v204
    v_mov_b32 v9, v12
    v_fma_f32 v10, v10, v13, v204
    v_pk_mul_f32 v[24:25], v[24:25], v[12:13] op_sel:[0,1] op_sel_hi:[1,1]
    v_pk_mul_f32 v[26:27], v[26:27], v[12:13] op_sel:[0,1] op_sel_hi:[1,1]
    v_pk_mul_f32 v[28:29], v[28:29], v[12:13] op_sel:[0,1] op_sel_hi:[1,1]
    v_pk_mul_f32 v[30:31], v[30:31], v[12:13] op_sel:[0,1] op_sel_hi:[1,1]
    v_cvt_pk_bf16_f32 v204, v204, v204
    s_nop 1
    v_and_b32_dpp v32, v204, v5 row_newbcast:0 row_mask:0xf bank_mask:0xf
    v_and_b32_dpp v33, v204, v6 row_newbcast:0 row_mask:0xf bank_mask:0xf
    v_and_b32_dpp v34, v204, v7 row_newbcast:0 row_mask:0xf bank_mask:0xf
    v_and_b32_dpp v35, v204, v8 row_newbcast:0 row_mask:0xf bank_mask:0xf
    s_nop 1
    v_mfma_f32_16x16x32_bf16 v[24:27], v[32:35], v[168:171], v[24:27]
    v_mfma_f32_16x16x32_bf16 v[28:31], v[32:35], v[172:175], v[28:31]
    v_and_b32_dpp v36, v204, v5 row_newbcast:4 row_mask:0xf bank_mask:0xf
    v_and_b32_dpp v37, v204, v6 row_newbcast:4 row_mask:0xf bank_mask:0xf
    v_and_b32_dpp v38, v204, v7 row_newbcast:4 row_mask:0xf bank_mask:0xf
    v_and_b32_dpp v39, v204, v8 row_newbcast:4 row_mask:0xf bank_mask:0xf
    s_nop 1
    v_mfma_f32_16x16x32_bf16 v[24:27], v[36:39], v[176:179], v[24:27]
    v_mfma_f32_16x16x32_bf16 v[28:31], v[36:39], v[180:183], v[28:31]
    v_and_b32_dpp v32, v204, v5 row_newbcast:8 row_mask:0xf bank_mask:0xf
    v_and_b32_dpp v33, v204, v6 row_newbcast:8 row_mask:0xf bank_mask:0xf
    v_and_b32_dpp v34, v204, v7 row_newbcast:8 row_mask:0xf bank_mask:0xf
    v_and_b32_dpp v35, v204, v8 row_newbcast:8 row_mask:0xf bank_mask:0xf
    s_nop 1
    v_mfma_f32_16x16x32_bf16 v[24:27], v[32:35], v[184:187], v[24:27]
    v_mfma_f32_16x16x32_bf16 v[28:31], v[32:35], v[188:191], v[28:31]
    v_and_b32_dpp v36, v204, v5 row_newbcast:12 row_mask:0xf bank_mask:0xf
    v_and_b32_dpp v37, v204, v6 row_newbcast:12 row_mask:0xf bank_mask:0xf
    v_and_b32_dpp v38, v204, v7 row_newbcast:12 row_mask:0xf bank_mask:0xf
    v_and_b32_dpp v39, v204, v8 row_newbcast:12 row_mask:0xf bank_mask:0xf
    s_nop 1
    v_mfma_f32_16x16x32_bf16 v[24:27], v[36:39], v[192:195], v[24:27]
    v_mfma_f32_16x16x32_bf16 v[28:31], v[36:39], v[196:199], v[28:31]
L_mfin:
    v_add_f32_dpp v10, v10, v10 row_ror:8 row_mask:0xf bank_mask:0xf
    s_nop 1
    v_add_f32_dpp v10, v10, v10 row_ror:4 row_mask:0xf bank_mask:0xf
    s_nop 1
    v_add_f32_dpp v10, v10, v10 row_ror:2 row_mask:0xf bank_mask:0xf
    s_nop 1
    v_add_f32_dpp v10, v10, v10 row_ror:1 row_mask:0xf bank_mask:0xf
    v_mov_b32 v11, v10
    s_nop 1
    v_permlane16_swap_b32 v10, v11
    v_add_f32 v10, v10, v11
    v_mov_b32 v11, v10
    s_nop 1
    v_permlane32_swap_b32 v10, v11
    v_add_f32 v10, v10, v11
    v_mul_f32 v10, 0.25, v10
    v_and_b32 v11, 15, v0
    v_lshrrev_b32 v12, 4, v0
    v_lshlrev_b32 v13, 4, v0
    s_lshl_b32 s48, s3, 10
    v_add_u32 v15, s48, v13
    s_lshl_b32 s48, s3, 3
    v_mov_b32 v18, s48
    v_mov_b32 v16, v9
    v_mov_b32 v17, v10
    ds_write_b64 v18, v[16:17] offset:576
    v_mov_b32 v18, 0
    v_mov_b32 v19, 1
    s_branch L_sdone
L_main:
    s_mov_b32 s63, 6
    s_and_b32 s48, s3, 1
    s_lshl_b32 s48, s48, 2
    s_mov_b32 s52, 1048576
    v_mov_b32 v11, s48
L_tw2:
    ds_read_b32 v12, v11 offset:560
    s_waitcnt lgkmcnt(0)
    v_readfirstlane_b32 s48, v12
    s_nop 0
    s_cmp_ge_u32 s48, 4
    s_cbranch_scc1 L_tw2_ok
    s_sleep 2
    s_sub_u32 s52, s52, 1
    s_cbranch_scc0 L_tw2
    s_endpgm
L_tw2_ok:
    s_add_u32 s100, s64, 900
    s_bitcmp1_b32 s2, 0
    s_cselect_b32 s48, 0, 30
    s_sub_u32 s100, s100, s48
    s_memrealtime s[60:61]
    s_add_u32 s62, s100, 60
L_top:
    s_waitcnt lgkmcnt(0)
    s_sub_u32 s48, s60, s100
    s_add_u32 s100, s100, 207
    s_sub_u32 s49, s60, s62
    s_add_u32 s62, s62, 222
    s_cmp_ge_i32 s49, 0
    s_cbranch_scc1 L_ck0
    s_cmp_ge_i32 s48, 0
    s_cbranch_scc1 L_ck1
    s_waitcnt vmcnt(9)
    v_mfma_f32_16x16x32_bf16 v[20:23], v[72:75], v[40:43], 0
    s_add_u32 s55, s47, 0
    buffer_load_dwordx4 v[72:75], v3, s[8:11], s55 offen offset:0 nt
    s_waitcnt vmcnt(9)
    v_mfma_f32_16x16x32_bf16 v[20:23], v[76:79], v[44:47], v[20:23]
    buffer_load_dwordx4 v[76:79], v3, s[8:11], s55 offen offset:256 nt
    s_waitcnt vmcnt(9)
    v_mfma_f32_16x16x32_bf16 v[20:23], v[80:83], v[48:51], v[20:23]
    buffer_load_dwordx4 v[80:83], v3, s[8:11], s55 offen offset:2048 nt
    s_waitcnt vmcnt(9)
    v_mfma_f32_16x16x32_bf16 v[20:23], v[84:87], v[52:55], v[20:23]
    buffer_load_dwordx4 v[84:87], v3, s[8:11], s55 offen offset:2304 nt
    s_waitcnt vmcnt(9)
    v_mfma_f32_16x16x32_bf16 v[20:23], v[88:91], v[56:59], v[20:23]
    buffer_load_dwordx4 v[88:91], v4, s[8:11], s55 offen offset:0 nt
    s_waitcnt vmcnt(9)
    v_mfma_f32_16x16x32_bf16 v[20:23], v[92:95], v[60:63], v[20:23]
    buffer_load_dwordx4 v[92:95], v4, s[8:11], s55 offen offset:256 nt
    s_waitcnt vmcnt(9)
    v_mfma_f32_16x16x32_bf16 v[20:23], v[96:99], v[64:67], v[20:23]
    buffer_load_dwordx4 v[96:99], v4, s[8:11], s55 offen offset:2048 nt
    s_waitcnt vmcnt(9)
    v_mfma_f32_16x16x32_bf16 v[20:23], v[100:103], v[68:71], v[20:23]
    buffer_load_dwordx4 v[100:103], v4, s[8:11], s55 offen offset:2304 nt
    s_waitcnt vmcnt(9)
    v_mfma_f32_16x16x32_bf16 v[32:35], v[104:107], v[40:43], 0
    s_add_u32 s55, s47, 32768
    buffer_load_dwordx4 v[104:107], v3, s[8:11], s55 offen offset:0 nt
    s_waitcnt vmcnt(9)
    v_mfma_f32_16x16x32_bf16 v[32:35], v[108:111], v[44:47], v[32:35]
    buffer_load_dwordx4 v[108:111], v3, s[8:11], s55 offen offset:256 nt
    s_waitcnt vmcnt(9)
    v_mfma_f32_16x16x32_bf16 v[32:35], v[112:115], v[48:51], v[32:35]
    buffer_load_dwordx4 v[112:115], v3, s[8:11], s55 offen offset:2048 nt
    v_mov_b32_dpp v11, v20 quad_perm:[0,0,0,0] row_mask:0xf bank_mask:0xf
    v_mov_b32_dpp v12, v21 quad_perm:[1,1,1,1] row_mask:0xf bank_mask:0xf
    v_mov_b32_dpp v13, v22 quad_perm:[2,2,2,2] row_mask:0xf bank_mask:0xf
    v_mov_b32_dpp v14, v23 quad_perm:[3,3,3,3] row_mask:0xf bank_mask:0xf
    s_waitcnt vmcnt(9)
    v_mfma_f32_16x16x32_bf16 v[32:35], v[116:119], v[52:55], v[32:35]
    buffer_load_dwordx4 v[116:119], v3, s[8:11], s55 offen offset:2304 nt
    v_add_f32 v11, v11, v12
    v_add_f32 v13, v13, v14
    v_add_f32 v11, v11, v13
    s_waitcnt vmcnt(9)
    v_mfma_f32_16x16x32_bf16 v[32:35], v[120:123], v[56:59], v[32:35]
    buffer_load_dwordx4 v[120:123], v4, s[8:11], s55 offen offset:0 nt
    v_cvt_pk_bf16_f32 v11, v11, v11
    v_and_b32 v11, 0xffff0000, v11
    v_mul_f32 v204, s51, v11
    s_waitcnt vmcnt(9)
    v_mfma_f32_16x16x32_bf16 v[32:35], v[124:127], v[60:63], v[32:35]
    buffer_load_dwordx4 v[124:127], v4, s[8:11], s55 offen offset:256 nt
    s_waitcnt vmcnt(9)
    v_mfma_f32_16x16x32_bf16 v[32:35], v[128:131], v[64:67], v[32:35]
    buffer_load_dwordx4 v[128:131], v4, s[8:11], s55 offen offset:2048 nt
    s_waitcnt vmcnt(9)
    v_mfma_f32_16x16x32_bf16 v[32:35], v[132:135], v[68:71], v[32:35]
    buffer_load_dwordx4 v[132:135], v4, s[8:11], s55 offen offset:2304 nt
    s_waitcnt vmcnt(9)
    v_mfma_f32_16x16x32_bf16 v[20:23], v[136:139], v[40:43], 0
    s_add_u32 s55, s47, 65536
    buffer_load_dwordx4 v[136:139], v3, s[8:11], s55 offen offset:0 nt
    s_waitcnt vmcnt(9)
    v_mfma_f32_16x16x32_bf16 v[20:23], v[140:143], v[44:47], v[20:23]
    buffer_load_dwordx4 v[140:143], v3, s[8:11], s55 offen offset:256 nt
    s_waitcnt vmcnt(9)
    v_mfma_f32_16x16x32_bf16 v[20:23], v[144:147], v[48:51], v[20:23]
    buffer_load_dwordx4 v[144:147], v3, s[8:11], s55 offen offset:2048 nt
    v_mov_b32_dpp v11, v32 quad_perm:[0,0,0,0] row_mask:0xf bank_mask:0xf
    v_mov_b32_dpp v12, v33 quad_perm:[1,1,1,1] row_mask:0xf bank_mask:0xf
    v_mov_b32_dpp v13, v34 quad_perm:[2,2,2,2] row_mask:0xf bank_mask:0xf
    v_mov_b32_dpp v14, v35 quad_perm:[3,3,3,3] row_mask:0xf bank_mask:0xf
    s_waitcnt vmcnt(9)
    v_mfma_f32_16x16x32_bf16 v[20:23], v[148:151], v[52:55], v[20:23]
    buffer_load_dwordx4 v[148:151], v3, s[8:11], s55 offen offset:2304 nt
    v_add_f32 v11, v11, v12
    v_add_f32 v13, v13, v14
    v_add_f32 v11, v11, v13
    s_waitcnt vmcnt(9)
    v_mfma_f32_16x16x32_bf16 v[20:23], v[152:155], v[56:59], v[20:23]
    buffer_load_dwordx4 v[152:155], v4, s[8:11], s55 offen offset:0 nt
    v_cvt_pk_bf16_f32 v11, v11, v11
    v_and_b32 v11, 0xffff0000, v11
    v_mul_f32 v205, s51, v11
    s_waitcnt vmcnt(9)
    v_mfma_f32_16x16x32_bf16 v[20:23], v[156:159], v[60:63], v[20:23]
    buffer_load_dwordx4 v[156:159], v4, s[8:11], s55 offen offset:256 nt
    s_waitcnt vmcnt(9)
    v_mfma_f32_16x16x32_bf16 v[20:23], v[160:163], v[64:67], v[20:23]
    buffer_load_dwordx4 v[160:163], v4, s[8:11], s55 offen offset:2048 nt
    s_waitcnt vmcnt(9)
    v_mfma_f32_16x16x32_bf16 v[20:23], v[164:167], v[68:71], v[20:23]
    buffer_load_dwordx4 v[164:167], v4, s[8:11], s55 offen offset:2304 nt
    s_waitcnt vmcnt(9)
    v_mfma_f32_16x16x32_bf16 v[32:35], v[168:171], v[40:43], 0
    s_add_u32 s55, s47, 98304
    buffer_load_dwordx4 v[168:171], v3, s[8:11], s55 offen offset:0 nt
    s_waitcnt vmcnt(9)
    v_mfma_f32_16x16x32_bf16 v[32:35], v[172:175], v[44:47], v[32:35]
    buffer_load_dwordx4 v[172:175], v3, s[8:11], s55 offen offset:256 nt
    s_waitcnt vmcnt(9)
    v_mfma_f32_16x16x32_bf16 v[32:35], v[176:179], v[48:51], v[32:35]
    buffer_load_dwordx4 v[176:179], v3, s[8:11], s55 offen offset:2048 nt
    v_mov_b32_dpp v11, v20 quad_perm:[0,0,0,0] row_mask:0xf bank_mask:0xf
    v_mov_b32_dpp v12, v21 quad_perm:[1,1,1,1] row_mask:0xf bank_mask:0xf
    v_mov_b32_dpp v13, v22 quad_perm:[2,2,2,2] row_mask:0xf bank_mask:0xf
    v_mov_b32_dpp v14, v23 quad_perm:[3,3,3,3] row_mask:0xf bank_mask:0xf
    s_waitcnt vmcnt(9)
    v_mfma_f32_16x16x32_bf16 v[32:35], v[180:183], v[52:55], v[32:35]
    buffer_load_dwordx4 v[180:183], v3, s[8:11], s55 offen offset:2304 nt
    v_add_f32 v11, v11, v12
    v_add_f32 v13, v13, v14
    v_add_f32 v11, v11, v13
    s_waitcnt vmcnt(9)
    v_mfma_f32_16x16x32_bf16 v[32:35], v[184:187], v[56:59], v[32:35]
    v_cvt_pk_bf16_f32 v11, v11, v11
    v_and_b32 v11, 0xffff0000, v11
    v_mul_f32 v206, s51, v11
    s_waitcnt vmcnt(9)
    v_mfma_f32_16x16x32_bf16 v[32:35], v[188:191], v[60:63], v[32:35]
    s_waitcnt vmcnt(9)
    v_mfma_f32_16x16x32_bf16 v[32:35], v[192:195], v[64:67], v[32:35]
    s_waitcnt vmcnt(9)
    v_mfma_f32_16x16x32_bf16 v[32:35], v[196:199], v[68:71], v[32:35]
    s_waitcnt vmcnt(9)
    buffer_load_dwordx4 v[184:187], v4, s[8:11], s55 offen offset:0 nt
    s_nop 5
    v_mov_b32_dpp v11, v32 quad_perm:[0,0,0,0] row_mask:0xf bank_mask:0xf
    v_mov_b32_dpp v12, v33 quad_perm:[1,1,1,1] row_mask:0xf bank_mask:0xf
    v_mov_b32_dpp v13, v34 quad_perm:[2,2,2,2] row_mask:0xf bank_mask:0xf
    v_mov_b32_dpp v14, v35 quad_perm:[3,3,3,3] row_mask:0xf bank_mask:0xf
    v_add_f32 v11, v11, v12
    v_add_f32 v13, v13, v14
    v_add_f32 v11, v11, v13
    v_cvt_pk_bf16_f32 v11, v11, v11
    v_and_b32 v11, 0xffff0000, v11
    v_mul_f32 v207, s51, v11
    s_memrealtime s[60:61]
    v_max3_f32 v12, v204, v205, v206
    v_max_f32 v12, v12, v207
    s_nop 1
    v_max_f32_dpp v12, v12, v12 row_ror:4 row_mask:0xf bank_mask:0xf
    s_nop 1
    v_max_f32_dpp v12, v12, v12 row_ror:8 row_mask:0xf bank_mask:0xf
    v_mov_b32 v13, v12
    s_nop 1
    v_permlane16_swap_b32 v12, v13
    v_max_f32 v12, v12, v13
    s_waitcnt vmcnt(9)
    buffer_load_dwordx4 v[188:191], v4, s[8:11], s55 offen offset:256 nt
    v_mov_b32 v13, v12
    s_nop 1
    v_permlane32_swap_b32 v12, v13
    v_max_f32 v12, v12, v13
    v_max_f32 v12, v12, v9
    v_sub_f32 v13, v9, v12
    v_sub_f32 v204, v204, v12
    v_sub_f32 v205, v205, v12
    v_sub_f32 v206, v206, v12
    v_sub_f32 v207, v207, v12
    v_exp_f32 v13, v13
    v_exp_f32 v204, v204
    v_exp_f32 v205, v205
    v_exp_f32 v206, v206
    v_exp_f32 v207, v207
    v_mov_b32 v9, v12
    s_waitcnt vmcnt(9)
    buffer_load_dwordx4 v[192:195], v4, s[8:11], s55 offen offset:2048 nt
    v_fma_f32 v10, v10, v13, v204
    v_pk_mul_f32 v[24:25], v[24:25], v[12:13] op_sel:[0,1] op_sel_hi:[1,1]
    v_pk_mul_f32 v[26:27], v[26:27], v[12:13] op_sel:[0,1] op_sel_hi:[1,1]
    v_pk_mul_f32 v[28:29], v[28:29], v[12:13] op_sel:[0,1] op_sel_hi:[1,1]
    v_pk_mul_f32 v[30:31], v[30:31], v[12:13] op_sel:[0,1] op_sel_hi:[1,1]
    v_add_f32 v10, v10, v205
    v_add_f32 v10, v10, v206
    v_add_f32 v10, v10, v207
    v_cvt_pk_bf16_f32 v204, v204, v204
    v_cvt_pk_bf16_f32 v205, v205, v205
    v_cvt_pk_bf16_f32 v206, v206, v206
    v_cvt_pk_bf16_f32 v207, v207, v207
    s_waitcnt vmcnt(9)
    buffer_load_dwordx4 v[196:199], v4, s[8:11], s55 offen offset:2304 nt
    s_cmp_eq_u32 s63, 4
    s_cselect_b32 s48, 0xfff84000, 0
    s_add_u32 s47, s47, s48
    s_add_u32 s47, s47, 131072
    s_branch L_ckx
L_ck0:
    s_waitcnt vmcnt(15)
    v_mfma_f32_16x16x32_bf16 v[20:23], v[72:75], v[40:43], 0
    s_add_u32 s55, s47, 0
    buffer_load_dwordx4 v[72:75], v3, s[8:11], s55 offen offset:0 nt
    s_waitcnt vmcnt(15)
    v_mfma_f32_16x16x32_bf16 v[20:23], v[76:79], v[44:47], v[20:23]
    buffer_load_dwordx4 v[76:79], v3, s[8:11], s55 offen offset:256 nt
    s_waitcnt vmcnt(15)
    v_mfma_f32_16x16x32_bf16 v[20:23], v[80:83], v[48:51], v[20:23]
    buffer_load_dwordx4 v[80:83], v3, s[8:11], s55 offen offset:2048 nt
    s_waitcnt vmcnt(15)
    v_mfma_f32_16x16x32_bf16 v[20:23], v[84:87], v[52:55], v[20:23]
    buffer_load_dwordx4 v[84:87], v3, s[8:11], s55 offen offset:2304 nt
    s_waitcnt vmcnt(15)
    v_mfma_f32_16x16x32_bf16 v[20:23], v[88:91], v[56:59], v[20:23]
    buffer_load_dwordx4 v[88:91], v4, s[8:11], s55 offen offset:0 nt
    s_waitcnt vmcnt(15)
    v_mfma_f32_16x16x32_bf16 v[20:23], v[92:95], v[60:63], v[20:23]
    buffer_load_dwordx4 v[92:95], v4, s[8:11], s55 offen offset:256 nt
    s_waitcnt vmcnt(15)
    v_mfma_f32_16x16x32_bf16 v[20:23], v[96:99], v[64:67], v[20:23]
    buffer_load_dwordx4 v[96:99], v4, s[8:11], s55 offen offset:2048 nt
    s_waitcnt vmcnt(15)
    v_mfma_f32_16x16x32_bf16 v[20:23], v[100:103], v[68:71], v[20:23]
    buffer_load_dwordx4 v[100:103], v4, s[8:11], s55 offen offset:2304 nt
    s_waitcnt vmcnt(15)
    v_mfma_f32_16x16x32_bf16 v[32:35], v[104:107], v[40:43], 0
    s_add_u32 s55, s47, 32768
    buffer_load_dwordx4 v[104:107], v3, s[8:11], s55 offen offset:0 nt
    s_waitcnt vmcnt(15)
    v_mfma_f32_16x16x32_bf16 v[32:35], v[108:111], v[44:47], v[32:35]
    buffer_load_dwordx4 v[108:111], v3, s[8:11], s55 offen offset:256 nt
    s_waitcnt vmcnt(15)
    v_mfma_f32_16x16x32_bf16 v[32:35], v[112:115], v[48:51], v[32:35]
    buffer_load_dwordx4 v[112:115], v3, s[8:11], s55 offen offset:2048 nt
    v_mov_b32_dpp v11, v20 quad_perm:[0,0,0,0] row_mask:0xf bank_mask:0xf
    v_mov_b32_dpp v12, v21 quad_perm:[1,1,1,1] row_mask:0xf bank_mask:0xf
    v_mov_b32_dpp v13, v22 quad_perm:[2,2,2,2] row_mask:0xf bank_mask:0xf
    v_mov_b32_dpp v14, v23 quad_perm:[3,3,3,3] row_mask:0xf bank_mask:0xf
    s_waitcnt vmcnt(15)
    v_mfma_f32_16x16x32_bf16 v[32:35], v[116:119], v[52:55], v[32:35]
    buffer_load_dwordx4 v[116:119], v3, s[8:11], s55 offen offset:2304 nt
    v_add_f32 v11, v11, v12
    v_add_f32 v13, v13, v14
    v_add_f32 v11, v11, v13
    s_waitcnt vmcnt(15)
    v_mfma_f32_16x16x32_bf16 v[32:35], v[120:123], v[56:59], v[32:35]
    buffer_load_dwordx4 v[120:123], v4, s[8:11], s55 offen offset:0 nt
    v_cvt_pk_bf16_f32 v11, v11, v11
    v_and_b32 v11, 0xffff0000, v11
    v_mul_f32 v204, s51, v11
    s_waitcnt vmcnt(15)
    v_mfma_f32_16x16x32_bf16 v[32:35], v[124:127], v[60:63], v[32:35]
    buffer_load_dwordx4 v[124:127], v4, s[8:11], s55 offen offset:256 nt
    s_waitcnt vmcnt(15)
    v_mfma_f32_16x16x32_bf16 v[32:35], v[128:131], v[64:67], v[32:35]
    buffer_load_dwordx4 v[128:131], v4, s[8:11], s55 offen offset:2048 nt
    s_waitcnt vmcnt(15)
    v_mfma_f32_16x16x32_bf16 v[32:35], v[132:135], v[68:71], v[32:35]
    buffer_load_dwordx4 v[132:135], v4, s[8:11], s55 offen offset:2304 nt
    s_waitcnt vmcnt(15)
    v_mfma_f32_16x16x32_bf16 v[20:23], v[136:139], v[40:43], 0
    s_add_u32 s55, s47, 65536
    buffer_load_dwordx4 v[136:139], v3, s[8:11], s55 offen offset:0 nt
    s_waitcnt vmcnt(15)
    v_mfma_f32_16x16x32_bf16 v[20:23], v[140:143], v[44:47], v[20:23]
    buffer_load_dwordx4 v[140:143], v3, s[8:11], s55 offen offset:256 nt
    s_waitcnt vmcnt(15)
    v_mfma_f32_16x16x32_bf16 v[20:23], v[144:147], v[48:51], v[20:23]
    buffer_load_dwordx4 v[144:147], v3, s[8:11], s55 offen offset:2048 nt
    v_mov_b32_dpp v11, v32 quad_perm:[0,0,0,0] row_mask:0xf bank_mask:0xf
    v_mov_b32_dpp v12, v33 quad_perm:[1,1,1,1] row_mask:0xf bank_mask:0xf
    v_mov_b32_dpp v13, v34 quad_perm:[2,2,2,2] row_mask:0xf bank_mask:0xf
    v_mov_b32_dpp v14, v35 quad_perm:[3,3,3,3] row_mask:0xf bank_mask:0xf
    s_waitcnt vmcnt(15)
    v_mfma_f32_16x16x32_bf16 v[20:23], v[148:151], v[52:55], v[20:23]
    buffer_load_dwordx4 v[148:151], v3, s[8:11], s55 offen offset:2304 nt
    v_add_f32 v11, v11, v12
    v_add_f32 v13, v13, v14
    v_add_f32 v11, v11, v13
    s_waitcnt vmcnt(15)
    v_mfma_f32_16x16x32_bf16 v[20:23], v[152:155], v[56:59], v[20:23]
    buffer_load_dwordx4 v[152:155], v4, s[8:11], s55 offen offset:0 nt
    v_cvt_pk_bf16_f32 v11, v11, v11
    v_and_b32 v11, 0xffff0000, v11
    v_mul_f32 v205, s51, v11
    s_waitcnt vmcnt(15)
    v_mfma_f32_16x16x32_bf16 v[20:23], v[156:159], v[60:63], v[20:23]
    buffer_load_dwordx4 v[156:159], v4, s[8:11], s55 offen offset:256 nt
    s_waitcnt vmcnt(15)
    v_mfma_f32_16x16x32_bf16 v[20:23], v[160:163], v[64:67], v[20:23]
    buffer_load_dwordx4 v[160:163], v4, s[8:11], s55 offen offset:2048 nt
    s_waitcnt vmcnt(15)
    v_mfma_f32_16x16x32_bf16 v[20:23], v[164:167], v[68:71], v[20:23]
    buffer_load_dwordx4 v[164:167], v4, s[8:11], s55 offen offset:2304 nt
    s_waitcnt vmcnt(15)
    v_mfma_f32_16x16x32_bf16 v[32:35], v[168:171], v[40:43], 0
    s_add_u32 s55, s47, 98304
    buffer_load_dwordx4 v[168:171], v3, s[8:11], s55 offen offset:0 nt
    s_waitcnt vmcnt(15)
    v_mfma_f32_16x16x32_bf16 v[32:35], v[172:175], v[44:47], v[32:35]
    buffer_load_dwordx4 v[172:175], v3, s[8:11], s55 offen offset:256 nt
    s_waitcnt vmcnt(15)
    v_mfma_f32_16x16x32_bf16 v[32:35], v[176:179], v[48:51], v[32:35]
    buffer_load_dwordx4 v[176:179], v3, s[8:11], s55 offen offset:2048 nt
    v_mov_b32_dpp v11, v20 quad_perm:[0,0,0,0] row_mask:0xf bank_mask:0xf
    v_mov_b32_dpp v12, v21 quad_perm:[1,1,1,1] row_mask:0xf bank_mask:0xf
    v_mov_b32_dpp v13, v22 quad_perm:[2,2,2,2] row_mask:0xf bank_mask:0xf
    v_mov_b32_dpp v14, v23 quad_perm:[3,3,3,3] row_mask:0xf bank_mask:0xf
    s_waitcnt vmcnt(15)
    v_mfma_f32_16x16x32_bf16 v[32:35], v[180:183], v[52:55], v[32:35]
    buffer_load_dwordx4 v[180:183], v3, s[8:11], s55 offen offset:2304 nt
    v_add_f32 v11, v11, v12
    v_add_f32 v13, v13, v14
    v_add_f32 v11, v11, v13
    s_waitcnt vmcnt(15)
    v_mfma_f32_16x16x32_bf16 v[32:35], v[184:187], v[56:59], v[32:35]
    v_cvt_pk_bf16_f32 v11, v11, v11
    v_and_b32 v11, 0xffff0000, v11
    v_mul_f32 v206, s51, v11
    s_waitcnt vmcnt(15)
    v_mfma_f32_16x16x32_bf16 v[32:35], v[188:191], v[60:63], v[32:35]
    s_waitcnt vmcnt(15)
    v_mfma_f32_16x16x32_bf16 v[32:35], v[192:195], v[64:67], v[32:35]
    s_waitcnt vmcnt(15)
    v_mfma_f32_16x16x32_bf16 v[32:35], v[196:199], v[68:71], v[32:35]
    s_waitcnt vmcnt(15)
    buffer_load_dwordx4 v[184:187], v4, s[8:11], s55 offen offset:0 nt
    s_nop 5
    v_mov_b32_dpp v11, v32 quad_perm:[0,0,0,0] row_mask:0xf bank_mask:0xf
    v_mov_b32_dpp v12, v33 quad_perm:[1,1,1,1] row_mask:0xf bank_mask:0xf
    v_mov_b32_dpp v13, v34 quad_perm:[2,2,2,2] row_mask:0xf bank_mask:0xf
    v_mov_b32_dpp v14, v35 quad_perm:[3,3,3,3] row_mask:0xf bank_mask:0xf
    v_add_f32 v11, v11, v12
    v_add_f32 v13, v13, v14
    v_add_f32 v11, v11, v13
    v_cvt_pk_bf16_f32 v11, v11, v11
    v_and_b32 v11, 0xffff0000, v11
    v_mul_f32 v207, s51, v11
    s_memrealtime s[60:61]
    v_max3_f32 v12, v204, v205, v206
    v_max_f32 v12, v12, v207
    s_nop 1
    v_max_f32_dpp v12, v12, v12 row_ror:4 row_mask:0xf bank_mask:0xf
    s_nop 1
    v_max_f32_dpp v12, v12, v12 row_ror:8 row_mask:0xf bank_mask:0xf
    v_mov_b32 v13, v12
    s_nop 1
    v_permlane16_swap_b32 v12, v13
    v_max_f32 v12, v12, v13
    s_waitcnt vmcnt(15)
    buffer_load_dwordx4 v[188:191], v4, s[8:11], s55 offen offset:256 nt
    v_mov_b32 v13, v12
    s_nop 1
    v_permlane32_swap_b32 v12, v13
    v_max_f32 v12, v12, v13
    v_max_f32 v12, v12, v9
    v_sub_f32 v13, v9, v12
    v_sub_f32 v204, v204, v12
    v_sub_f32 v205, v205, v12
    v_sub_f32 v206, v206, v12
    v_sub_f32 v207, v207, v12
    v_exp_f32 v13, v13
    v_exp_f32 v204, v204
    v_exp_f32 v205, v205
    v_exp_f32 v206, v206
    v_exp_f32 v207, v207
    v_mov_b32 v9, v12
    s_waitcnt vmcnt(15)
    buffer_load_dwordx4 v[192:195], v4, s[8:11], s55 offen offset:2048 nt
    v_fma_f32 v10, v10, v13, v204
    v_pk_mul_f32 v[24:25], v[24:25], v[12:13] op_sel:[0,1] op_sel_hi:[1,1]
    v_pk_mul_f32 v[26:27], v[26:27], v[12:13] op_sel:[0,1] op_sel_hi:[1,1]
    v_pk_mul_f32 v[28:29], v[28:29], v[12:13] op_sel:[0,1] op_sel_hi:[1,1]
    v_pk_mul_f32 v[30:31], v[30:31], v[12:13] op_sel:[0,1] op_sel_hi:[1,1]
    v_add_f32 v10, v10, v205
    v_add_f32 v10, v10, v206
    v_add_f32 v10, v10, v207
    v_cvt_pk_bf16_f32 v204, v204, v204
    v_cvt_pk_bf16_f32 v205, v205, v205
    v_cvt_pk_bf16_f32 v206, v206, v206
    v_cvt_pk_bf16_f32 v207, v207, v207
    s_waitcnt vmcnt(15)
    buffer_load_dwordx4 v[196:199], v4, s[8:11], s55 offen offset:2304 nt
    s_cmp_eq_u32 s63, 4
    s_cselect_b32 s48, 0xfff84000, 0
    s_add_u32 s47, s47, s48
    s_add_u32 s47, s47, 131072
    s_branch L_ckx
L_ck1:
    s_waitcnt vmcnt(11)
    v_mfma_f32_16x16x32_bf16 v[20:23], v[72:75], v[40:43], 0
    s_add_u32 s55, s47, 0
    buffer_load_dwordx4 v[72:75], v3, s[8:11], s55 offen offset:0 nt
    s_waitcnt vmcnt(11)
    v_mfma_f32_16x16x32_bf16 v[20:23], v[76:79], v[44:47], v[20:23]
    buffer_load_dwordx4 v[76:79], v3, s[8:11], s55 offen offset:256 nt
    s_waitcnt vmcnt(11)
    v_mfma_f32_16x16x32_bf16 v[20:23], v[80:83], v[48:51], v[20:23]
    buffer_load_dwordx4 v[80:83], v3, s[8:11], s55 offen offset:2048 nt
    s_waitcnt vmcnt(11)
    v_mfma_f32_16x16x32_bf16 v[20:23], v[84:87], v[52:55], v[20:23]
    buffer_load_dwordx4 v[84:87], v3, s[8:11], s55 offen offset:2304 nt
    s_waitcnt vmcnt(11)
    v_mfma_f32_16x16x32_bf16 v[20:23], v[88:91], v[56:59], v[20:23]
    buffer_load_dwordx4 v[88:91], v4, s[8:11], s55 offen offset:0 nt
    s_waitcnt vmcnt(11)
    v_mfma_f32_16x16x32_bf16 v[20:23], v[92:95], v[60:63], v[20:23]
    buffer_load_dwordx4 v[92:95], v4, s[8:11], s55 offen offset:256 nt
    s_waitcnt vmcnt(11)
    v_mfma_f32_16x16x32_bf16 v[20:23], v[96:99], v[64:67], v[20:23]
    buffer_load_dwordx4 v[96:99], v4, s[8:11], s55 offen offset:2048 nt
    s_waitcnt vmcnt(11)
    v_mfma_f32_16x16x32_bf16 v[20:23], v[100:103], v[68:71], v[20:23]
    buffer_load_dwordx4 v[100:103], v4, s[8:11], s55 offen offset:2304 nt
    s_waitcnt vmcnt(11)
    v_mfma_f32_16x16x32_bf16 v[32:35], v[104:107], v[40:43], 0
    s_add_u32 s55, s47, 32768
    buffer_load_dwordx4 v[104:107], v3, s[8:11], s55 offen offset:0 nt
    s_waitcnt vmcnt(11)
    v_mfma_f32_16x16x32_bf16 v[32:35], v[108:111], v[44:47], v[32:35]
    buffer_load_dwordx4 v[108:111], v3, s[8:11], s55 offen offset:256 nt
    s_waitcnt vmcnt(11)
    v_mfma_f32_16x16x32_bf16 v[32:35], v[112:115], v[48:51], v[32:35]
    buffer_load_dwordx4 v[112:115], v3, s[8:11], s55 offen offset:2048 nt
    v_mov_b32_dpp v11, v20 quad_perm:[0,0,0,0] row_mask:0xf bank_mask:0xf
    v_mov_b32_dpp v12, v21 quad_perm:[1,1,1,1] row_mask:0xf bank_mask:0xf
    v_mov_b32_dpp v13, v22 quad_perm:[2,2,2,2] row_mask:0xf bank_mask:0xf
    v_mov_b32_dpp v14, v23 quad_perm:[3,3,3,3] row_mask:0xf bank_mask:0xf
    s_waitcnt vmcnt(11)
    v_mfma_f32_16x16x32_bf16 v[32:35], v[116:119], v[52:55], v[32:35]
    buffer_load_dwordx4 v[116:119], v3, s[8:11], s55 offen offset:2304 nt
    v_add_f32 v11, v11, v12
    v_add_f32 v13, v13, v14
    v_add_f32 v11, v11, v13
    s_waitcnt vmcnt(11)
    v_mfma_f32_16x16x32_bf16 v[32:35], v[120:123], v[56:59], v[32:35]
    buffer_load_dwordx4 v[120:123], v4, s[8:11], s55 offen offset:0 nt
    v_cvt_pk_bf16_f32 v11, v11, v11
    v_and_b32 v11, 0xffff0000, v11
    v_mul_f32 v204, s51, v11
    s_waitcnt vmcnt(11)
    v_mfma_f32_16x16x32_bf16 v[32:35], v[124:127], v[60:63], v[32:35]
    buffer_load_dwordx4 v[124:127], v4, s[8:11], s55 offen offset:256 nt
    s_waitcnt vmcnt(11)
    v_mfma_f32_16x16x32_bf16 v[32:35], v[128:131], v[64:67], v[32:35]
    buffer_load_dwordx4 v[128:131], v4, s[8:11], s55 offen offset:2048 nt
    s_waitcnt vmcnt(11)
    v_mfma_f32_16x16x32_bf16 v[32:35], v[132:135], v[68:71], v[32:35]
    buffer_load_dwordx4 v[132:135], v4, s[8:11], s55 offen offset:2304 nt
    s_waitcnt vmcnt(11)
    v_mfma_f32_16x16x32_bf16 v[20:23], v[136:139], v[40:43], 0
    s_add_u32 s55, s47, 65536
    buffer_load_dwordx4 v[136:139], v3, s[8:11], s55 offen offset:0 nt
    s_waitcnt vmcnt(11)
    v_mfma_f32_16x16x32_bf16 v[20:23], v[140:143], v[44:47], v[20:23]
    buffer_load_dwordx4 v[140:143], v3, s[8:11], s55 offen offset:256 nt
    s_waitcnt vmcnt(11)
    v_mfma_f32_16x16x32_bf16 v[20:23], v[144:147], v[48:51], v[20:23]
    buffer_load_dwordx4 v[144:147], v3, s[8:11], s55 offen offset:2048 nt
    v_mov_b32_dpp v11, v32 quad_perm:[0,0,0,0] row_mask:0xf bank_mask:0xf
    v_mov_b32_dpp v12, v33 quad_perm:[1,1,1,1] row_mask:0xf bank_mask:0xf
    v_mov_b32_dpp v13, v34 quad_perm:[2,2,2,2] row_mask:0xf bank_mask:0xf
    v_mov_b32_dpp v14, v35 quad_perm:[3,3,3,3] row_mask:0xf bank_mask:0xf
    s_waitcnt vmcnt(11)
    v_mfma_f32_16x16x32_bf16 v[20:23], v[148:151], v[52:55], v[20:23]
    buffer_load_dwordx4 v[148:151], v3, s[8:11], s55 offen offset:2304 nt
    v_add_f32 v11, v11, v12
    v_add_f32 v13, v13, v14
    v_add_f32 v11, v11, v13
    s_waitcnt vmcnt(11)
    v_mfma_f32_16x16x32_bf16 v[20:23], v[152:155], v[56:59], v[20:23]
    buffer_load_dwordx4 v[152:155], v4, s[8:11], s55 offen offset:0 nt
    v_cvt_pk_bf16_f32 v11, v11, v11
    v_and_b32 v11, 0xffff0000, v11
    v_mul_f32 v205, s51, v11
    s_waitcnt vmcnt(11)
    v_mfma_f32_16x16x32_bf16 v[20:23], v[156:159], v[60:63], v[20:23]
    buffer_load_dwordx4 v[156:159], v4, s[8:11], s55 offen offset:256 nt
    s_waitcnt vmcnt(11)
    v_mfma_f32_16x16x32_bf16 v[20:23], v[160:163], v[64:67], v[20:23]
    buffer_load_dwordx4 v[160:163], v4, s[8:11], s55 offen offset:2048 nt
    s_waitcnt vmcnt(11)
    v_mfma_f32_16x16x32_bf16 v[20:23], v[164:167], v[68:71], v[20:23]
    buffer_load_dwordx4 v[164:167], v4, s[8:11], s55 offen offset:2304 nt
    s_waitcnt vmcnt(11)
    v_mfma_f32_16x16x32_bf16 v[32:35], v[168:171], v[40:43], 0
    s_add_u32 s55, s47, 98304
    buffer_load_dwordx4 v[168:171], v3, s[8:11], s55 offen offset:0 nt
    s_waitcnt vmcnt(11)
    v_mfma_f32_16x16x32_bf16 v[32:35], v[172:175], v[44:47], v[32:35]
    buffer_load_dwordx4 v[172:175], v3, s[8:11], s55 offen offset:256 nt
    s_waitcnt vmcnt(11)
    v_mfma_f32_16x16x32_bf16 v[32:35], v[176:179], v[48:51], v[32:35]
    buffer_load_dwordx4 v[176:179], v3, s[8:11], s55 offen offset:2048 nt
    v_mov_b32_dpp v11, v20 quad_perm:[0,0,0,0] row_mask:0xf bank_mask:0xf
    v_mov_b32_dpp v12, v21 quad_perm:[1,1,1,1] row_mask:0xf bank_mask:0xf
    v_mov_b32_dpp v13, v22 quad_perm:[2,2,2,2] row_mask:0xf bank_mask:0xf
    v_mov_b32_dpp v14, v23 quad_perm:[3,3,3,3] row_mask:0xf bank_mask:0xf
    s_waitcnt vmcnt(11)
    v_mfma_f32_16x16x32_bf16 v[32:35], v[180:183], v[52:55], v[32:35]
    buffer_load_dwordx4 v[180:183], v3, s[8:11], s55 offen offset:2304 nt
    v_add_f32 v11, v11, v12
    v_add_f32 v13, v13, v14
    v_add_f32 v11, v11, v13
    s_waitcnt vmcnt(11)
    v_mfma_f32_16x16x32_bf16 v[32:35], v[184:187], v[56:59], v[32:35]
    v_cvt_pk_bf16_f32 v11, v11, v11
    v_and_b32 v11, 0xffff0000, v11
    v_mul_f32 v206, s51, v11
    s_waitcnt vmcnt(11)
    v_mfma_f32_16x16x32_bf16 v[32:35], v[188:191], v[60:63], v[32:35]
    s_waitcnt vmcnt(11)
    v_mfma_f32_16x16x32_bf16 v[32:35], v[192:195], v[64:67], v[32:35]
    s_waitcnt vmcnt(11)
    v_mfma_f32_16x16x32_bf16 v[32:35], v[196:199], v[68:71], v[32:35]
    s_waitcnt vmcnt(11)
    buffer_load_dwordx4 v[184:187], v4, s[8:11], s55 offen offset:0 nt
    s_nop 5
    v_mov_b32_dpp v11, v32 quad_perm:[0,0,0,0] row_mask:0xf bank_mask:0xf
    v_mov_b32_dpp v12, v33 quad_perm:[1,1,1,1] row_mask:0xf bank_mask:0xf
    v_mov_b32_dpp v13, v34 quad_perm:[2,2,2,2] row_mask:0xf bank_mask:0xf
    v_mov_b32_dpp v14, v35 quad_perm:[3,3,3,3] row_mask:0xf bank_mask:0xf
    v_add_f32 v11, v11, v12
    v_add_f32 v13, v13, v14
    v_add_f32 v11, v11, v13
    v_cvt_pk_bf16_f32 v11, v11, v11
    v_and_b32 v11, 0xffff0000, v11
    v_mul_f32 v207, s51, v11
    s_memrealtime s[60:61]
    v_max3_f32 v12, v204, v205, v206
    v_max_f32 v12, v12, v207
    s_nop 1
    v_max_f32_dpp v12, v12, v12 row_ror:4 row_mask:0xf bank_mask:0xf
    s_nop 1
    v_max_f32_dpp v12, v12, v12 row_ror:8 row_mask:0xf bank_mask:0xf
    v_mov_b32 v13, v12
    s_nop 1
    v_permlane16_swap_b32 v12, v13
    v_max_f32 v12, v12, v13
    s_waitcnt vmcnt(11)
    buffer_load_dwordx4 v[188:191], v4, s[8:11], s55 offen offset:256 nt
    v_mov_b32 v13, v12
    s_nop 1
    v_permlane32_swap_b32 v12, v13
    v_max_f32 v12, v12, v13
    v_max_f32 v12, v12, v9
    v_sub_f32 v13, v9, v12
    v_sub_f32 v204, v204, v12
    v_sub_f32 v205, v205, v12
    v_sub_f32 v206, v206, v12
    v_sub_f32 v207, v207, v12
    v_exp_f32 v13, v13
    v_exp_f32 v204, v204
    v_exp_f32 v205, v205
    v_exp_f32 v206, v206
    v_exp_f32 v207, v207
    v_mov_b32 v9, v12
    s_waitcnt vmcnt(11)
    buffer_load_dwordx4 v[192:195], v4, s[8:11], s55 offen offset:2048 nt
    v_fma_f32 v10, v10, v13, v204
    v_pk_mul_f32 v[24:25], v[24:25], v[12:13] op_sel:[0,1] op_sel_hi:[1,1]
    v_pk_mul_f32 v[26:27], v[26:27], v[12:13] op_sel:[0,1] op_sel_hi:[1,1]
    v_pk_mul_f32 v[28:29], v[28:29], v[12:13] op_sel:[0,1] op_sel_hi:[1,1]
    v_pk_mul_f32 v[30:31], v[30:31], v[12:13] op_sel:[0,1] op_sel_hi:[1,1]
    v_add_f32 v10, v10, v205
    v_add_f32 v10, v10, v206
    v_add_f32 v10, v10, v207
    v_cvt_pk_bf16_f32 v204, v204, v204
    v_cvt_pk_bf16_f32 v205, v205, v205
    v_cvt_pk_bf16_f32 v206, v206, v206
    v_cvt_pk_bf16_f32 v207, v207, v207
    s_waitcnt vmcnt(11)
    buffer_load_dwordx4 v[196:199], v4, s[8:11], s55 offen offset:2304 nt
    s_cmp_eq_u32 s63, 4
    s_cselect_b32 s48, 0xfff84000, 0
    s_add_u32 s47, s47, s48
    s_add_u32 s47, s47, 131072
L_ckx:
    s_waitcnt lgkmcnt(0)
    s_sub_u32 s48, s60, s100
    s_add_u32 s100, s100, 207
    s_sub_u32 s49, s60, s62
    s_add_u32 s62, s62, 222
    s_cmp_ge_i32 s49, 0
    s_cbranch_scc1 L_cv0
    s_cmp_ge_i32 s48, 0
    s_cbranch_scc1 L_cv1
    v_and_b32_dpp v32, v204, v5 row_newbcast:0 row_mask:0xf bank_mask:0xf
    v_and_b32_dpp v33, v204, v6 row_newbcast:0 row_mask:0xf bank_mask:0xf
    v_and_b32_dpp v34, v204, v7 row_newbcast:0 row_mask:0xf bank_mask:0xf
    v_and_b32_dpp v35, v204, v8 row_newbcast:0 row_mask:0xf bank_mask:0xf
    s_waitcnt vmcnt(9)
    s_nop 0
    v_mfma_f32_16x16x32_bf16 v[24:27], v[32:35], v[72:75], v[24:27]
    s_add_u32 s55, s47, 0
    buffer_load_dwordx4 v[72:75], v1, s[4:7], s55 offen offset:0 nt
    s_waitcnt vmcnt(9)
    v_mfma_f32_16x16x32_bf16 v[28:31], v[32:35], v[76:79], v[28:31]
    buffer_load_dwordx4 v[76:79], v1, s[4:7], s55 offen offset:256 nt
    v_and_b32_dpp v36, v204, v5 row_newbcast:4 row_mask:0xf bank_mask:0xf
    v_and_b32_dpp v37, v204, v6 row_newbcast:4 row_mask:0xf bank_mask:0xf
    v_and_b32_dpp v38, v204, v7 row_newbcast:4 row_mask:0xf bank_mask:0xf
    v_and_b32_dpp v39, v204, v8 row_newbcast:4 row_mask:0xf bank_mask:0xf
    s_waitcnt vmcnt(9)
    s_nop 0
    v_mfma_f32_16x16x32_bf16 v[24:27], v[36:39], v[80:83], v[24:27]
    buffer_load_dwordx4 v[80:83], v1, s[4:7], s55 offen offset:2048 nt
    s_waitcnt vmcnt(9)
    v_mfma_f32_16x16x32_bf16 v[28:31], v[36:39], v[84:87], v[28:31]
    buffer_load_dwordx4 v[84:87], v1, s[4:7], s55 offen offset:2304 nt
    v_and_b32_dpp v32, v204, v5 row_newbcast:8 row_mask:0xf bank_mask:0xf
    v_and_b32_dpp v33, v204, v6 row_newbcast:8 row_mask:0xf bank_mask:0xf
    v_and_b32_dpp v34, v204, v7 row_newbcast:8 row_mask:0xf bank_mask:0xf
    v_and_b32_dpp v35, v204, v8 row_newbcast:8 row_mask:0xf bank_mask:0xf
    s_waitcnt vmcnt(9)
    s_nop 0
    v_mfma_f32_16x16x32_bf16 v[24:27], v[32:35], v[88:91], v[24:27]
    buffer_load_dwordx4 v[88:91], v2, s[4:7], s55 offen offset:0 nt
    s_waitcnt vmcnt(9)
    v_mfma_f32_16x16x32_bf16 v[28:31], v[32:35], v[92:95], v[28:31]
    buffer_load_dwordx4 v[92:95], v2, s[4:7], s55 offen offset:256 nt
    v_and_b32_dpp v36, v204, v5 row_newbcast:12 row_mask:0xf bank_mask:0xf
    v_and_b32_dpp v37, v204, v6 row_newbcast:12 row_mask:0xf bank_mask:0xf
    v_and_b32_dpp v38, v204, v7 row_newbcast:12 row_mask:0xf bank_mask:0xf
    v_and_b32_dpp v39, v204, v8 row_newbcast:12 row_mask:0xf bank_mask:0xf
    s_waitcnt vmcnt(9)
    s_nop 0
    v_mfma_f32_16x16x32_bf16 v[24:27], v[36:39], v[96:99], v[24:27]
    buffer_load_dwordx4 v[96:99], v2, s[4:7], s55 offen offset:2048 nt
    s_waitcnt vmcnt(9)
    v_mfma_f32_16x16x32_bf16 v[28:31], v[36:39], v[100:103], v[28:31]
    buffer_load_dwordx4 v[100:103], v2, s[4:7], s55 offen offset:2304 nt
    v_and_b32_dpp v32, v205, v5 row_newbcast:0 row_mask:0xf bank_mask:0xf
    v_and_b32_dpp v33, v205, v6 row_newbcast:0 row_mask:0xf bank_mask:0xf
    v_and_b32_dpp v34, v205, v7 row_newbcast:0 row_mask:0xf bank_mask:0xf
    v_and_b32_dpp v35, v205, v8 row_newbcast:0 row_mask:0xf bank_mask:0xf
    s_waitcnt vmcnt(9)
    s_nop 0
    v_mfma_f32_16x16x32_bf16 v[24:27], v[32:35], v[104:107], v[24:27]
    s_add_u32 s55, s47, 32768
    buffer_load_dwordx4 v[104:107], v1, s[4:7], s55 offen offset:0 nt
    s_waitcnt vmcnt(9)
    v_mfma_f32_16x16x32_bf16 v[28:31], v[32:35], v[108:111], v[28:31]
    buffer_load_dwordx4 v[108:111], v1, s[4:7], s55 offen offset:256 nt
    v_and_b32_dpp v36, v205, v5 row_newbcast:4 row_mask:0xf bank_mask:0xf
    v_and_b32_dpp v37, v205, v6 row_newbcast:4 row_mask:0xf bank_mask:0xf
    v_and_b32_dpp v38, v205, v7 row_newbcast:4 row_mask:0xf bank_mask:0xf
    v_and_b32_dpp v39, v205, v8 row_newbcast:4 row_mask:0xf bank_mask:0xf
    s_waitcnt vmcnt(9)
    s_nop 0
    v_mfma_f32_16x16x32_bf16 v[24:27], v[36:39], v[112:115], v[24:27]
    buffer_load_dwordx4 v[112:115], v1, s[4:7], s55 offen offset:2048 nt
    s_waitcnt vmcnt(9)
    v_mfma_f32_16x16x32_bf16 v[28:31], v[36:39], v[116:119], v[28:31]
    buffer_load_dwordx4 v[116:119], v1, s[4:7], s55 offen offset:2304 nt
    v_and_b32_dpp v32, v205, v5 row_newbcast:8 row_mask:0xf bank_mask:0xf
    v_and_b32_dpp v33, v205, v6 row_newbcast:8 row_mask:0xf bank_mask:0xf
    v_and_b32_dpp v34, v205, v7 row_newbcast:8 row_mask:0xf bank_mask:0xf
    v_and_b32_dpp v35, v205, v8 row_newbcast:8 row_mask:0xf bank_mask:0xf
    s_waitcnt vmcnt(9)
    s_nop 0
    v_mfma_f32_16x16x32_bf16 v[24:27], v[32:35], v[120:123], v[24:27]
    buffer_load_dwordx4 v[120:123], v2, s[4:7], s55 offen offset:0 nt
    s_waitcnt vmcnt(9)
    v_mfma_f32_16x16x32_bf16 v[28:31], v[32:35], v[124:127], v[28:31]
    buffer_load_dwordx4 v[124:127], v2, s[4:7], s55 offen offset:256 nt
    v_and_b32_dpp v36, v205, v5 row_newbcast:12 row_mask:0xf bank_mask:0xf
    v_and_b32_dpp v37, v205, v6 row_newbcast:12 row_mask:0xf bank_mask:0xf
    v_and_b32_dpp v38, v205, v7 row_newbcast:12 row_mask:0xf bank_mask:0xf
    v_and_b32_dpp v39, v205, v8 row_newbcast:12 row_mask:0xf bank_mask:0xf
    s_waitcnt vmcnt(9)
    s_nop 0
    v_mfma_f32_16x16x32_bf16 v[24:27], v[36:39], v[128:131], v[24:27]
    buffer_load_dwordx4 v[128:131], v2, s[4:7], s55 offen offset:2048 nt
    s_waitcnt vmcnt(9)
    v_mfma_f32_16x16x32_bf16 v[28:31], v[36:39], v[132:135], v[28:31]
    buffer_load_dwordx4 v[132:135], v2, s[4:7], s55 offen offset:2304 nt
    v_and_b32_dpp v32, v206, v5 row_newbcast:0 row_mask:0xf bank_mask:0xf
    v_and_b32_dpp v33, v206, v6 row_newbcast:0 row_mask:0xf bank_mask:0xf
    v_and_b32_dpp v34, v206, v7 row_newbcast:0 row_mask:0xf bank_mask:0xf
    v_and_b32_dpp v35, v206, v8 row_newbcast:0 row_mask:0xf bank_mask:0xf
    s_waitcnt vmcnt(9)
    s_nop 0
    v_mfma_f32_16x16x32_bf16 v[24:27], v[32:35], v[136:139], v[24:27]
    s_add_u32 s55, s47, 65536
    buffer_load_dwordx4 v[136:139], v1, s[4:7], s55 offen offset:0 nt
    s_waitcnt vmcnt(9)
    v_mfma_f32_16x16x32_bf16 v[28:31], v[32:35], v[140:143], v[28:31]
    buffer_load_dwordx4 v[140:143], v1, s[4:7], s55 offen offset:256 nt
    v_and_b32_dpp v36, v206, v5 row_newbcast:4 row_mask:0xf bank_mask:0xf
    v_and_b32_dpp v37, v206, v6 row_newbcast:4 row_mask:0xf bank_mask:0xf
    v_and_b32_dpp v38, v206, v7 row_newbcast:4 row_mask:0xf bank_mask:0xf
    v_and_b32_dpp v39, v206, v8 row_newbcast:4 row_mask:0xf bank_mask:0xf
    s_waitcnt vmcnt(9)
    s_nop 0
    v_mfma_f32_16x16x32_bf16 v[24:27], v[36:39], v[144:147], v[24:27]
    buffer_load_dwordx4 v[144:147], v1, s[4:7], s55 offen offset:2048 nt
    s_waitcnt vmcnt(9)
    v_mfma_f32_16x16x32_bf16 v[28:31], v[36:39], v[148:151], v[28:31]
    buffer_load_dwordx4 v[148:151], v1, s[4:7], s55 offen offset:2304 nt
    v_and_b32_dpp v32, v206, v5 row_newbcast:8 row_mask:0xf bank_mask:0xf
    v_and_b32_dpp v33, v206, v6 row_newbcast:8 row_mask:0xf bank_mask:0xf
    v_and_b32_dpp v34, v206, v7 row_newbcast:8 row_mask:0xf bank_mask:0xf
    v_and_b32_dpp v35, v206, v8 row_newbcast:8 row_mask:0xf bank_mask:0xf
    s_waitcnt vmcnt(9)
    s_nop 0
    v_mfma_f32_16x16x32_bf16 v[24:27], v[32:35], v[152:155], v[24:27]
    buffer_load_dwordx4 v[152:155], v2, s[4:7], s55 offen offset:0 nt
    s_waitcnt vmcnt(9)
    v_mfma_f32_16x16x32_bf16 v[28:31], v[32:35], v[156:159], v[28:31]
    buffer_load_dwordx4 v[156:159], v2, s[4:7], s55 offen offset:256 nt
    v_and_b32_dpp v36, v206, v5 row_newbcast:12 row_mask:0xf bank_mask:0xf
    v_and_b32_dpp v37, v206, v6 row_newbcast:12 row_mask:0xf bank_mask:0xf
    v_and_b32_dpp v38, v206, v7 row_newbcast:12 row_mask:0xf bank_mask:0xf
    v_and_b32_dpp v39, v206, v8 row_newbcast:12 row_mask:0xf bank_mask:0xf
    s_waitcnt vmcnt(9)
    s_nop 0
    v_mfma_f32_16x16x32_bf16 v[24:27], v[36:39], v[160:163], v[24:27]
    buffer_load_dwordx4 v[160:163], v2, s[4:7], s55 offen offset:2048 nt
    s_waitcnt vmcnt(9)
    v_mfma_f32_16x16x32_bf16 v[28:31], v[36:39], v[164:167], v[28:31]
    buffer_load_dwordx4 v[164:167], v2, s[4:7], s55 offen offset:2304 nt
    v_and_b32_dpp v32, v207, v5 row_newbcast:0 row_mask:0xf bank_mask:0xf
    v_and_b32_dpp v33, v207, v6 row_newbcast:0 row_mask:0xf bank_mask:0xf
    v_and_b32_dpp v34, v207, v7 row_newbcast:0 row_mask:0xf bank_mask:0xf
    v_and_b32_dpp v35, v207, v8 row_newbcast:0 row_mask:0xf bank_mask:0xf
    s_waitcnt vmcnt(9)
    s_nop 0
    v_mfma_f32_16x16x32_bf16 v[24:27], v[32:35], v[168:171], v[24:27]
    s_add_u32 s55, s47, 98304
    buffer_load_dwordx4 v[168:171], v1, s[4:7], s55 offen offset:0 nt
    s_waitcnt vmcnt(9)
    v_mfma_f32_16x16x32_bf16 v[28:31], v[32:35], v[172:175], v[28:31]
    buffer_load_dwordx4 v[172:175], v1, s[4:7], s55 offen offset:256 nt
    v_and_b32_dpp v36, v207, v5 row_newbcast:4 row_mask:0xf bank_mask:0xf
    v_and_b32_dpp v37, v207, v6 row_newbcast:4 row_mask:0xf bank_mask:0xf
    v_and_b32_dpp v38, v207, v7 row_newbcast:4 row_mask:0xf bank_mask:0xf
    v_and_b32_dpp v39, v207, v8 row_newbcast:4 row_mask:0xf bank_mask:0xf
    s_waitcnt vmcnt(9)
    s_nop 0
    v_mfma_f32_16x16x32_bf16 v[24:27], v[36:39], v[176:179], v[24:27]
    buffer_load_dwordx4 v[176:179], v1, s[4:7], s55 offen offset:2048 nt
    s_waitcnt vmcnt(9)
    v_mfma_f32_16x16x32_bf16 v[28:31], v[36:39], v[180:183], v[28:31]
    buffer_load_dwordx4 v[180:183], v1, s[4:7], s55 offen offset:2304 nt
    v_and_b32_dpp v32, v207, v5 row_newbcast:8 row_mask:0xf bank_mask:0xf
    v_and_b32_dpp v33, v207, v6 row_newbcast:8 row_mask:0xf bank_mask:0xf
    v_and_b32_dpp v34, v207, v7 row_newbcast:8 row_mask:0xf bank_mask:0xf
    v_and_b32_dpp v35, v207, v8 row_newbcast:8 row_mask:0xf bank_mask:0xf
    s_waitcnt vmcnt(9)
    s_nop 0
    v_mfma_f32_16x16x32_bf16 v[24:27], v[32:35], v[184:187], v[24:27]
    buffer_load_dwordx4 v[184:187], v2, s[4:7], s55 offen offset:0 nt
    s_waitcnt vmcnt(9)
    v_mfma_f32_16x16x32_bf16 v[28:31], v[32:35], v[188:191], v[28:31]
    buffer_load_dwordx4 v[188:191], v2, s[4:7], s55 offen offset:256 nt
    v_and_b32_dpp v36, v207, v5 row_newbcast:12 row_mask:0xf bank_mask:0xf
    v_and_b32_dpp v37, v207, v6 row_newbcast:12 row_mask:0xf bank_mask:0xf
    v_and_b32_dpp v38, v207, v7 row_newbcast:12 row_mask:0xf bank_mask:0xf
    v_and_b32_dpp v39, v207, v8 row_newbcast:12 row_mask:0xf bank_mask:0xf
    s_waitcnt vmcnt(9)
    s_nop 0
    v_mfma_f32_16x16x32_bf16 v[24:27], v[36:39], v[192:195], v[24:27]
    buffer_load_dwordx4 v[192:195], v2, s[4:7], s55 offen offset:2048 nt
    s_memrealtime s[60:61]
    s_waitcnt vmcnt(9)
    v_mfma_f32_16x16x32_bf16 v[28:31], v[36:39], v[196:199], v[28:31]
    buffer_load_dwordx4 v[196:199], v2, s[4:7], s55 offen offset:2304 nt
    s_branch L_cvx
L_cv0:
    v_and_b32_dpp v32, v204, v5 row_newbcast:0 row_mask:0xf bank_mask:0xf
    v_and_b32_dpp v33, v204, v6 row_newbcast:0 row_mask:0xf bank_mask:0xf
    v_and_b32_dpp v34, v204, v7 row_newbcast:0 row_mask:0xf bank_mask:0xf
    v_and_b32_dpp v35, v204, v8 row_newbcast:0 row_mask:0xf bank_mask:0xf
    s_waitcnt vmcnt(15)
    s_nop 0
    v_mfma_f32_16x16x32_bf16 v[24:27], v[32:35], v[72:75], v[24:27]
    s_add_u32 s55, s47, 0
    buffer_load_dwordx4 v[72:75], v1, s[4:7], s55 offen offset:0 nt
    s_waitcnt vmcnt(15)
    v_mfma_f32_16x16x32_bf16 v[28:31], v[32:35], v[76:79], v[28:31]
    buffer_load_dwordx4 v[76:79], v1, s[4:7], s55 offen offset:256 nt
    v_and_b32_dpp v36, v204, v5 row_newbcast:4 row_mask:0xf bank_mask:0xf
    v_and_b32_dpp v37, v204, v6 row_newbcast:4 row_mask:0xf bank_mask:0xf
    v_and_b32_dpp v38, v204, v7 row_newbcast:4 row_mask:0xf bank_mask:0xf
    v_and_b32_dpp v39, v204, v8 row_newbcast:4 row_mask:0xf bank_mask:0xf
    s_waitcnt vmcnt(15)
    s_nop 0
    v_mfma_f32_16x16x32_bf16 v[24:27], v[36:39], v[80:83], v[24:27]
    buffer_load_dwordx4 v[80:83], v1, s[4:7], s55 offen offset:2048 nt
    s_waitcnt vmcnt(15)
    v_mfma_f32_16x16x32_bf16 v[28:31], v[36:39], v[84:87], v[28:31]
    buffer_load_dwordx4 v[84:87], v1, s[4:7], s55 offen offset:2304 nt
    v_and_b32_dpp v32, v204, v5 row_newbcast:8 row_mask:0xf bank_mask:0xf
    v_and_b32_dpp v33, v204, v6 row_newbcast:8 row_mask:0xf bank_mask:0xf
    v_and_b32_dpp v34, v204, v7 row_newbcast:8 row_mask:0xf bank_mask:0xf
    v_and_b32_dpp v35, v204, v8 row_newbcast:8 row_mask:0xf bank_mask:0xf
    s_waitcnt vmcnt(15)
    s_nop 0
    v_mfma_f32_16x16x32_bf16 v[24:27], v[32:35], v[88:91], v[24:27]
    buffer_load_dwordx4 v[88:91], v2, s[4:7], s55 offen offset:0 nt
    s_waitcnt vmcnt(15)
    v_mfma_f32_16x16x32_bf16 v[28:31], v[32:35], v[92:95], v[28:31]
    buffer_load_dwordx4 v[92:95], v2, s[4:7], s55 offen offset:256 nt
    v_and_b32_dpp v36, v204, v5 row_newbcast:12 row_mask:0xf bank_mask:0xf
    v_and_b32_dpp v37, v204, v6 row_newbcast:12 row_mask:0xf bank_mask:0xf
    v_and_b32_dpp v38, v204, v7 row_newbcast:12 row_mask:0xf bank_mask:0xf
    v_and_b32_dpp v39, v204, v8 row_newbcast:12 row_mask:0xf bank_mask:0xf
    s_waitcnt vmcnt(15)
    s_nop 0
    v_mfma_f32_16x16x32_bf16 v[24:27], v[36:39], v[96:99], v[24:27]
    buffer_load_dwordx4 v[96:99], v2, s[4:7], s55 offen offset:2048 nt
    s_waitcnt vmcnt(15)
    v_mfma_f32_16x16x32_bf16 v[28:31], v[36:39], v[100:103], v[28:31]
    buffer_load_dwordx4 v[100:103], v2, s[4:7], s55 offen offset:2304 nt
    v_and_b32_dpp v32, v205, v5 row_newbcast:0 row_mask:0xf bank_mask:0xf
    v_and_b32_dpp v33, v205, v6 row_newbcast:0 row_mask:0xf bank_mask:0xf
    v_and_b32_dpp v34, v205, v7 row_newbcast:0 row_mask:0xf bank_mask:0xf
    v_and_b32_dpp v35, v205, v8 row_newbcast:0 row_mask:0xf bank_mask:0xf
    s_waitcnt vmcnt(15)
    s_nop 0
    v_mfma_f32_16x16x32_bf16 v[24:27], v[32:35], v[104:107], v[24:27]
    s_add_u32 s55, s47, 32768
    buffer_load_dwordx4 v[104:107], v1, s[4:7], s55 offen offset:0 nt
    s_waitcnt vmcnt(15)
    v_mfma_f32_16x16x32_bf16 v[28:31], v[32:35], v[108:111], v[28:31]
    buffer_load_dwordx4 v[108:111], v1, s[4:7], s55 offen offset:256 nt
    v_and_b32_dpp v36, v205, v5 row_newbcast:4 row_mask:0xf bank_mask:0xf
    v_and_b32_dpp v37, v205, v6 row_newbcast:4 row_mask:0xf bank_mask:0xf
    v_and_b32_dpp v38, v205, v7 row_newbcast:4 row_mask:0xf bank_mask:0xf
    v_and_b32_dpp v39, v205, v8 row_newbcast:4 row_mask:0xf bank_mask:0xf
    s_waitcnt vmcnt(15)
    s_nop 0
    v_mfma_f32_16x16x32_bf16 v[24:27], v[36:39], v[112:115], v[24:27]
    buffer_load_dwordx4 v[112:115], v1, s[4:7], s55 offen offset:2048 nt
    s_waitcnt vmcnt(15)
    v_mfma_f32_16x16x32_bf16 v[28:31], v[36:39], v[116:119], v[28:31]
    buffer_load_dwordx4 v[116:119], v1, s[4:7], s55 offen offset:2304 nt
    v_and_b32_dpp v32, v205, v5 row_newbcast:8 row_mask:0xf bank_mask:0xf
    v_and_b32_dpp v33, v205, v6 row_newbcast:8 row_mask:0xf bank_mask:0xf
    v_and_b32_dpp v34, v205, v7 row_newbcast:8 row_mask:0xf bank_mask:0xf
    v_and_b32_dpp v35, v205, v8 row_newbcast:8 row_mask:0xf bank_mask:0xf
    s_waitcnt vmcnt(15)
    s_nop 0
    v_mfma_f32_16x16x32_bf16 v[24:27], v[32:35], v[120:123], v[24:27]
    buffer_load_dwordx4 v[120:123], v2, s[4:7], s55 offen offset:0 nt
    s_waitcnt vmcnt(15)
    v_mfma_f32_16x16x32_bf16 v[28:31], v[32:35], v[124:127], v[28:31]
    buffer_load_dwordx4 v[124:127], v2, s[4:7], s55 offen offset:256 nt
    v_and_b32_dpp v36, v205, v5 row_newbcast:12 row_mask:0xf bank_mask:0xf
    v_and_b32_dpp v37, v205, v6 row_newbcast:12 row_mask:0xf bank_mask:0xf
    v_and_b32_dpp v38, v205, v7 row_newbcast:12 row_mask:0xf bank_mask:0xf
    v_and_b32_dpp v39, v205, v8 row_newbcast:12 row_mask:0xf bank_mask:0xf
    s_waitcnt vmcnt(15)
    s_nop 0
    v_mfma_f32_16x16x32_bf16 v[24:27], v[36:39], v[128:131], v[24:27]
    buffer_load_dwordx4 v[128:131], v2, s[4:7], s55 offen offset:2048 nt
    s_waitcnt vmcnt(15)
    v_mfma_f32_16x16x32_bf16 v[28:31], v[36:39], v[132:135], v[28:31]
    buffer_load_dwordx4 v[132:135], v2, s[4:7], s55 offen offset:2304 nt
    v_and_b32_dpp v32, v206, v5 row_newbcast:0 row_mask:0xf bank_mask:0xf
    v_and_b32_dpp v33, v206, v6 row_newbcast:0 row_mask:0xf bank_mask:0xf
    v_and_b32_dpp v34, v206, v7 row_newbcast:0 row_mask:0xf bank_mask:0xf
    v_and_b32_dpp v35, v206, v8 row_newbcast:0 row_mask:0xf bank_mask:0xf
    s_waitcnt vmcnt(15)
    s_nop 0
    v_mfma_f32_16x16x32_bf16 v[24:27], v[32:35], v[136:139], v[24:27]
    s_add_u32 s55, s47, 65536
    buffer_load_dwordx4 v[136:139], v1, s[4:7], s55 offen offset:0 nt
    s_waitcnt vmcnt(15)
    v_mfma_f32_16x16x32_bf16 v[28:31], v[32:35], v[140:143], v[28:31]
    buffer_load_dwordx4 v[140:143], v1, s[4:7], s55 offen offset:256 nt
    v_and_b32_dpp v36, v206, v5 row_newbcast:4 row_mask:0xf bank_mask:0xf
    v_and_b32_dpp v37, v206, v6 row_newbcast:4 row_mask:0xf bank_mask:0xf
    v_and_b32_dpp v38, v206, v7 row_newbcast:4 row_mask:0xf bank_mask:0xf
    v_and_b32_dpp v39, v206, v8 row_newbcast:4 row_mask:0xf bank_mask:0xf
    s_waitcnt vmcnt(15)
    s_nop 0
    v_mfma_f32_16x16x32_bf16 v[24:27], v[36:39], v[144:147], v[24:27]
    buffer_load_dwordx4 v[144:147], v1, s[4:7], s55 offen offset:2048 nt
    s_waitcnt vmcnt(15)
    v_mfma_f32_16x16x32_bf16 v[28:31], v[36:39], v[148:151], v[28:31]
    buffer_load_dwordx4 v[148:151], v1, s[4:7], s55 offen offset:2304 nt
    v_and_b32_dpp v32, v206, v5 row_newbcast:8 row_mask:0xf bank_mask:0xf
    v_and_b32_dpp v33, v206, v6 row_newbcast:8 row_mask:0xf bank_mask:0xf
    v_and_b32_dpp v34, v206, v7 row_newbcast:8 row_mask:0xf bank_mask:0xf
    v_and_b32_dpp v35, v206, v8 row_newbcast:8 row_mask:0xf bank_mask:0xf
    s_waitcnt vmcnt(15)
    s_nop 0
    v_mfma_f32_16x16x32_bf16 v[24:27], v[32:35], v[152:155], v[24:27]
    buffer_load_dwordx4 v[152:155], v2, s[4:7], s55 offen offset:0 nt
    s_waitcnt vmcnt(15)
    v_mfma_f32_16x16x32_bf16 v[28:31], v[32:35], v[156:159], v[28:31]
    buffer_load_dwordx4 v[156:159], v2, s[4:7], s55 offen offset:256 nt
    v_and_b32_dpp v36, v206, v5 row_newbcast:12 row_mask:0xf bank_mask:0xf
    v_and_b32_dpp v37, v206, v6 row_newbcast:12 row_mask:0xf bank_mask:0xf
    v_and_b32_dpp v38, v206, v7 row_newbcast:12 row_mask:0xf bank_mask:0xf
    v_and_b32_dpp v39, v206, v8 row_newbcast:12 row_mask:0xf bank_mask:0xf
    s_waitcnt vmcnt(15)
    s_nop 0
    v_mfma_f32_16x16x32_bf16 v[24:27], v[36:39], v[160:163], v[24:27]
    buffer_load_dwordx4 v[160:163], v2, s[4:7], s55 offen offset:2048 nt
    s_waitcnt vmcnt(15)
    v_mfma_f32_16x16x32_bf16 v[28:31], v[36:39], v[164:167], v[28:31]
    buffer_load_dwordx4 v[164:167], v2, s[4:7], s55 offen offset:2304 nt
    v_and_b32_dpp v32, v207, v5 row_newbcast:0 row_mask:0xf bank_mask:0xf
    v_and_b32_dpp v33, v207, v6 row_newbcast:0 row_mask:0xf bank_mask:0xf
    v_and_b32_dpp v34, v207, v7 row_newbcast:0 row_mask:0xf bank_mask:0xf
    v_and_b32_dpp v35, v207, v8 row_newbcast:0 row_mask:0xf bank_mask:0xf
    s_waitcnt vmcnt(15)
    s_nop 0
    v_mfma_f32_16x16x32_bf16 v[24:27], v[32:35], v[168:171], v[24:27]
    s_add_u32 s55, s47, 98304
    buffer_load_dwordx4 v[168:171], v1, s[4:7], s55 offen offset:0 nt
    s_waitcnt vmcnt(15)
    v_mfma_f32_16x16x32_bf16 v[28:31], v[32:35], v[172:175], v[28:31]
    buffer_load_dwordx4 v[172:175], v1, s[4:7], s55 offen offset:256 nt
    v_and_b32_dpp v36, v207, v5 row_newbcast:4 row_mask:0xf bank_mask:0xf
    v_and_b32_dpp v37, v207, v6 row_newbcast:4 row_mask:0xf bank_mask:0xf
    v_and_b32_dpp v38, v207, v7 row_newbcast:4 row_mask:0xf bank_mask:0xf
    v_and_b32_dpp v39, v207, v8 row_newbcast:4 row_mask:0xf bank_mask:0xf
    s_waitcnt vmcnt(15)
    s_nop 0
    v_mfma_f32_16x16x32_bf16 v[24:27], v[36:39], v[176:179], v[24:27]
    buffer_load_dwordx4 v[176:179], v1, s[4:7], s55 offen offset:2048 nt
    s_waitcnt vmcnt(15)
    v_mfma_f32_16x16x32_bf16 v[28:31], v[36:39], v[180:183], v[28:31]
    buffer_load_dwordx4 v[180:183], v1, s[4:7], s55 offen offset:2304 nt
    v_and_b32_dpp v32, v207, v5 row_newbcast:8 row_mask:0xf bank_mask:0xf
    v_and_b32_dpp v33, v207, v6 row_newbcast:8 row_mask:0xf bank_mask:0xf
    v_and_b32_dpp v34, v207, v7 row_newbcast:8 row_mask:0xf bank_mask:0xf
    v_and_b32_dpp v35, v207, v8 row_newbcast:8 row_mask:0xf bank_mask:0xf
    s_waitcnt vmcnt(15)
    s_nop 0
    v_mfma_f32_16x16x32_bf16 v[24:27], v[32:35], v[184:187], v[24:27]
    buffer_load_dwordx4 v[184:187], v2, s[4:7], s55 offen offset:0 nt
    s_waitcnt vmcnt(15)
    v_mfma_f32_16x16x32_bf16 v[28:31], v[32:35], v[188:191], v[28:31]
    buffer_load_dwordx4 v[188:191], v2, s[4:7], s55 offen offset:256 nt
    v_and_b32_dpp v36, v207, v5 row_newbcast:12 row_mask:0xf bank_mask:0xf
    v_and_b32_dpp v37, v207, v6 row_newbcast:12 row_mask:0xf bank_mask:0xf
    v_and_b32_dpp v38, v207, v7 row_newbcast:12 row_mask:0xf bank_mask:0xf
    v_and_b32_dpp v39, v207, v8 row_newbcast:12 row_mask:0xf bank_mask:0xf
    s_waitcnt vmcnt(15)
    s_nop 0
    v_mfma_f32_16x16x32_bf16 v[24:27], v[36:39], v[192:195], v[24:27]
    buffer_load_dwordx4 v[192:195], v2, s[4:7], s55 offen offset:2048 nt
    s_memrealtime s[60:61]
    s_waitcnt vmcnt(15)
    v_mfma_f32_16x16x32_bf16 v[28:31], v[36:39], v[196:199], v[28:31]
    buffer_load_dwordx4 v[196:199], v2, s[4:7], s55 offen offset:2304 nt
    s_branch L_cvx
L_cv1:
    v_and_b32_dpp v32, v204, v5 row_newbcast:0 row_mask:0xf bank_mask:0xf
    v_and_b32_dpp v33, v204, v6 row_newbcast:0 row_mask:0xf bank_mask:0xf
    v_and_b32_dpp v34, v204, v7 row_newbcast:0 row_mask:0xf bank_mask:0xf
    v_and_b32_dpp v35, v204, v8 row_newbcast:0 row_mask:0xf bank_mask:0xf
    s_waitcnt vmcnt(11)
    s_nop 0
    v_mfma_f32_16x16x32_bf16 v[24:27], v[32:35], v[72:75], v[24:27]
    s_add_u32 s55, s47, 0
    buffer_load_dwordx4 v[72:75], v1, s[4:7], s55 offen offset:0 nt
    s_waitcnt vmcnt(11)
    v_mfma_f32_16x16x32_bf16 v[28:31], v[32:35], v[76:79], v[28:31]
    buffer_load_dwordx4 v[76:79], v1, s[4:7], s55 offen offset:256 nt
    v_and_b32_dpp v36, v204, v5 row_newbcast:4 row_mask:0xf bank_mask:0xf
    v_and_b32_dpp v37, v204, v6 row_newbcast:4 row_mask:0xf bank_mask:0xf
    v_and_b32_dpp v38, v204, v7 row_newbcast:4 row_mask:0xf bank_mask:0xf
    v_and_b32_dpp v39, v204, v8 row_newbcast:4 row_mask:0xf bank_mask:0xf
    s_waitcnt vmcnt(11)
    s_nop 0
    v_mfma_f32_16x16x32_bf16 v[24:27], v[36:39], v[80:83], v[24:27]
    buffer_load_dwordx4 v[80:83], v1, s[4:7], s55 offen offset:2048 nt
    s_waitcnt vmcnt(11)
    v_mfma_f32_16x16x32_bf16 v[28:31], v[36:39], v[84:87], v[28:31]
    buffer_load_dwordx4 v[84:87], v1, s[4:7], s55 offen offset:2304 nt
    v_and_b32_dpp v32, v204, v5 row_newbcast:8 row_mask:0xf bank_mask:0xf
    v_and_b32_dpp v33, v204, v6 row_newbcast:8 row_mask:0xf bank_mask:0xf
    v_and_b32_dpp v34, v204, v7 row_newbcast:8 row_mask:0xf bank_mask:0xf
    v_and_b32_dpp v35, v204, v8 row_newbcast:8 row_mask:0xf bank_mask:0xf
    s_waitcnt vmcnt(11)
    s_nop 0
    v_mfma_f32_16x16x32_bf16 v[24:27], v[32:35], v[88:91], v[24:27]
    buffer_load_dwordx4 v[88:91], v2, s[4:7], s55 offen offset:0 nt
    s_waitcnt vmcnt(11)
    v_mfma_f32_16x16x32_bf16 v[28:31], v[32:35], v[92:95], v[28:31]
    buffer_load_dwordx4 v[92:95], v2, s[4:7], s55 offen offset:256 nt
    v_and_b32_dpp v36, v204, v5 row_newbcast:12 row_mask:0xf bank_mask:0xf
    v_and_b32_dpp v37, v204, v6 row_newbcast:12 row_mask:0xf bank_mask:0xf
    v_and_b32_dpp v38, v204, v7 row_newbcast:12 row_mask:0xf bank_mask:0xf
    v_and_b32_dpp v39, v204, v8 row_newbcast:12 row_mask:0xf bank_mask:0xf
    s_waitcnt vmcnt(11)
    s_nop 0
    v_mfma_f32_16x16x32_bf16 v[24:27], v[36:39], v[96:99], v[24:27]
    buffer_load_dwordx4 v[96:99], v2, s[4:7], s55 offen offset:2048 nt
    s_waitcnt vmcnt(11)
    v_mfma_f32_16x16x32_bf16 v[28:31], v[36:39], v[100:103], v[28:31]
    buffer_load_dwordx4 v[100:103], v2, s[4:7], s55 offen offset:2304 nt
    v_and_b32_dpp v32, v205, v5 row_newbcast:0 row_mask:0xf bank_mask:0xf
    v_and_b32_dpp v33, v205, v6 row_newbcast:0 row_mask:0xf bank_mask:0xf
    v_and_b32_dpp v34, v205, v7 row_newbcast:0 row_mask:0xf bank_mask:0xf
    v_and_b32_dpp v35, v205, v8 row_newbcast:0 row_mask:0xf bank_mask:0xf
    s_waitcnt vmcnt(11)
    s_nop 0
    v_mfma_f32_16x16x32_bf16 v[24:27], v[32:35], v[104:107], v[24:27]
    s_add_u32 s55, s47, 32768
    buffer_load_dwordx4 v[104:107], v1, s[4:7], s55 offen offset:0 nt
    s_waitcnt vmcnt(11)
    v_mfma_f32_16x16x32_bf16 v[28:31], v[32:35], v[108:111], v[28:31]
    buffer_load_dwordx4 v[108:111], v1, s[4:7], s55 offen offset:256 nt
    v_and_b32_dpp v36, v205, v5 row_newbcast:4 row_mask:0xf bank_mask:0xf
    v_and_b32_dpp v37, v205, v6 row_newbcast:4 row_mask:0xf bank_mask:0xf
    v_and_b32_dpp v38, v205, v7 row_newbcast:4 row_mask:0xf bank_mask:0xf
    v_and_b32_dpp v39, v205, v8 row_newbcast:4 row_mask:0xf bank_mask:0xf
    s_waitcnt vmcnt(11)
    s_nop 0
    v_mfma_f32_16x16x32_bf16 v[24:27], v[36:39], v[112:115], v[24:27]
    buffer_load_dwordx4 v[112:115], v1, s[4:7], s55 offen offset:2048 nt
    s_waitcnt vmcnt(11)
    v_mfma_f32_16x16x32_bf16 v[28:31], v[36:39], v[116:119], v[28:31]
    buffer_load_dwordx4 v[116:119], v1, s[4:7], s55 offen offset:2304 nt
    v_and_b32_dpp v32, v205, v5 row_newbcast:8 row_mask:0xf bank_mask:0xf
    v_and_b32_dpp v33, v205, v6 row_newbcast:8 row_mask:0xf bank_mask:0xf
    v_and_b32_dpp v34, v205, v7 row_newbcast:8 row_mask:0xf bank_mask:0xf
    v_and_b32_dpp v35, v205, v8 row_newbcast:8 row_mask:0xf bank_mask:0xf
    s_waitcnt vmcnt(11)
    s_nop 0
    v_mfma_f32_16x16x32_bf16 v[24:27], v[32:35], v[120:123], v[24:27]
    buffer_load_dwordx4 v[120:123], v2, s[4:7], s55 offen offset:0 nt
    s_waitcnt vmcnt(11)
    v_mfma_f32_16x16x32_bf16 v[28:31], v[32:35], v[124:127], v[28:31]
    buffer_load_dwordx4 v[124:127], v2, s[4:7], s55 offen offset:256 nt
    v_and_b32_dpp v36, v205, v5 row_newbcast:12 row_mask:0xf bank_mask:0xf
    v_and_b32_dpp v37, v205, v6 row_newbcast:12 row_mask:0xf bank_mask:0xf
    v_and_b32_dpp v38, v205, v7 row_newbcast:12 row_mask:0xf bank_mask:0xf
    v_and_b32_dpp v39, v205, v8 row_newbcast:12 row_mask:0xf bank_mask:0xf
    s_waitcnt vmcnt(11)
    s_nop 0
    v_mfma_f32_16x16x32_bf16 v[24:27], v[36:39], v[128:131], v[24:27]
    buffer_load_dwordx4 v[128:131], v2, s[4:7], s55 offen offset:2048 nt
    s_waitcnt vmcnt(11)
    v_mfma_f32_16x16x32_bf16 v[28:31], v[36:39], v[132:135], v[28:31]
    buffer_load_dwordx4 v[132:135], v2, s[4:7], s55 offen offset:2304 nt
    v_and_b32_dpp v32, v206, v5 row_newbcast:0 row_mask:0xf bank_mask:0xf
    v_and_b32_dpp v33, v206, v6 row_newbcast:0 row_mask:0xf bank_mask:0xf
    v_and_b32_dpp v34, v206, v7 row_newbcast:0 row_mask:0xf bank_mask:0xf
    v_and_b32_dpp v35, v206, v8 row_newbcast:0 row_mask:0xf bank_mask:0xf
    s_waitcnt vmcnt(11)
    s_nop 0
    v_mfma_f32_16x16x32_bf16 v[24:27], v[32:35], v[136:139], v[24:27]
    s_add_u32 s55, s47, 65536
    buffer_load_dwordx4 v[136:139], v1, s[4:7], s55 offen offset:0 nt
    s_waitcnt vmcnt(11)
    v_mfma_f32_16x16x32_bf16 v[28:31], v[32:35], v[140:143], v[28:31]
    buffer_load_dwordx4 v[140:143], v1, s[4:7], s55 offen offset:256 nt
    v_and_b32_dpp v36, v206, v5 row_newbcast:4 row_mask:0xf bank_mask:0xf
    v_and_b32_dpp v37, v206, v6 row_newbcast:4 row_mask:0xf bank_mask:0xf
    v_and_b32_dpp v38, v206, v7 row_newbcast:4 row_mask:0xf bank_mask:0xf
    v_and_b32_dpp v39, v206, v8 row_newbcast:4 row_mask:0xf bank_mask:0xf
    s_waitcnt vmcnt(11)
    s_nop 0
    v_mfma_f32_16x16x32_bf16 v[24:27], v[36:39], v[144:147], v[24:27]
    buffer_load_dwordx4 v[144:147], v1, s[4:7], s55 offen offset:2048 nt
    s_waitcnt vmcnt(11)
    v_mfma_f32_16x16x32_bf16 v[28:31], v[36:39], v[148:151], v[28:31]
    buffer_load_dwordx4 v[148:151], v1, s[4:7], s55 offen offset:2304 nt
    v_and_b32_dpp v32, v206, v5 row_newbcast:8 row_mask:0xf bank_mask:0xf
    v_and_b32_dpp v33, v206, v6 row_newbcast:8 row_mask:0xf bank_mask:0xf
    v_and_b32_dpp v34, v206, v7 row_newbcast:8 row_mask:0xf bank_mask:0xf
    v_and_b32_dpp v35, v206, v8 row_newbcast:8 row_mask:0xf bank_mask:0xf
    s_waitcnt vmcnt(11)
    s_nop 0
    v_mfma_f32_16x16x32_bf16 v[24:27], v[32:35], v[152:155], v[24:27]
    buffer_load_dwordx4 v[152:155], v2, s[4:7], s55 offen offset:0 nt
    s_waitcnt vmcnt(11)
    v_mfma_f32_16x16x32_bf16 v[28:31], v[32:35], v[156:159], v[28:31]
    buffer_load_dwordx4 v[156:159], v2, s[4:7], s55 offen offset:256 nt
    v_and_b32_dpp v36, v206, v5 row_newbcast:12 row_mask:0xf bank_mask:0xf
    v_and_b32_dpp v37, v206, v6 row_newbcast:12 row_mask:0xf bank_mask:0xf
    v_and_b32_dpp v38, v206, v7 row_newbcast:12 row_mask:0xf bank_mask:0xf
    v_and_b32_dpp v39, v206, v8 row_newbcast:12 row_mask:0xf bank_mask:0xf
    s_waitcnt vmcnt(11)
    s_nop 0
    v_mfma_f32_16x16x32_bf16 v[24:27], v[36:39], v[160:163], v[24:27]
    buffer_load_dwordx4 v[160:163], v2, s[4:7], s55 offen offset:2048 nt
    s_waitcnt vmcnt(11)
    v_mfma_f32_16x16x32_bf16 v[28:31], v[36:39], v[164:167], v[28:31]
    buffer_load_dwordx4 v[164:167], v2, s[4:7], s55 offen offset:2304 nt
    v_and_b32_dpp v32, v207, v5 row_newbcast:0 row_mask:0xf bank_mask:0xf
    v_and_b32_dpp v33, v207, v6 row_newbcast:0 row_mask:0xf bank_mask:0xf
    v_and_b32_dpp v34, v207, v7 row_newbcast:0 row_mask:0xf bank_mask:0xf
    v_and_b32_dpp v35, v207, v8 row_newbcast:0 row_mask:0xf bank_mask:0xf
    s_waitcnt vmcnt(11)
    s_nop 0
    v_mfma_f32_16x16x32_bf16 v[24:27], v[32:35], v[168:171], v[24:27]
    s_add_u32 s55, s47, 98304
    buffer_load_dwordx4 v[168:171], v1, s[4:7], s55 offen offset:0 nt
    s_waitcnt vmcnt(11)
    v_mfma_f32_16x16x32_bf16 v[28:31], v[32:35], v[172:175], v[28:31]
    buffer_load_dwordx4 v[172:175], v1, s[4:7], s55 offen offset:256 nt
    v_and_b32_dpp v36, v207, v5 row_newbcast:4 row_mask:0xf bank_mask:0xf
    v_and_b32_dpp v37, v207, v6 row_newbcast:4 row_mask:0xf bank_mask:0xf
    v_and_b32_dpp v38, v207, v7 row_newbcast:4 row_mask:0xf bank_mask:0xf
    v_and_b32_dpp v39, v207, v8 row_newbcast:4 row_mask:0xf bank_mask:0xf
    s_waitcnt vmcnt(11)
    s_nop 0
    v_mfma_f32_16x16x32_bf16 v[24:27], v[36:39], v[176:179], v[24:27]
    buffer_load_dwordx4 v[176:179], v1, s[4:7], s55 offen offset:2048 nt
    s_waitcnt vmcnt(11)
    v_mfma_f32_16x16x32_bf16 v[28:31], v[36:39], v[180:183], v[28:31]
    buffer_load_dwordx4 v[180:183], v1, s[4:7], s55 offen offset:2304 nt
    v_and_b32_dpp v32, v207, v5 row_newbcast:8 row_mask:0xf bank_mask:0xf
    v_and_b32_dpp v33, v207, v6 row_newbcast:8 row_mask:0xf bank_mask:0xf
    v_and_b32_dpp v34, v207, v7 row_newbcast:8 row_mask:0xf bank_mask:0xf
    v_and_b32_dpp v35, v207, v8 row_newbcast:8 row_mask:0xf bank_mask:0xf
    s_waitcnt vmcnt(11)
    s_nop 0
    v_mfma_f32_16x16x32_bf16 v[24:27], v[32:35], v[184:187], v[24:27]
    buffer_load_dwordx4 v[184:187], v2, s[4:7], s55 offen offset:0 nt
    s_waitcnt vmcnt(11)
    v_mfma_f32_16x16x32_bf16 v[28:31], v[32:35], v[188:191], v[28:31]
    buffer_load_dwordx4 v[188:191], v2, s[4:7], s55 offen offset:256 nt
    v_and_b32_dpp v36, v207, v5 row_newbcast:12 row_mask:0xf bank_mask:0xf
    v_and_b32_dpp v37, v207, v6 row_newbcast:12 row_mask:0xf bank_mask:0xf
    v_and_b32_dpp v38, v207, v7 row_newbcast:12 row_mask:0xf bank_mask:0xf
    v_and_b32_dpp v39, v207, v8 row_newbcast:12 row_mask:0xf bank_mask:0xf
    s_waitcnt vmcnt(11)
    s_nop 0
    v_mfma_f32_16x16x32_bf16 v[24:27], v[36:39], v[192:195], v[24:27]
    buffer_load_dwordx4 v[192:195], v2, s[4:7], s55 offen offset:2048 nt
    s_memrealtime s[60:61]
    s_waitcnt vmcnt(11)
    v_mfma_f32_16x16x32_bf16 v[28:31], v[36:39], v[196:199], v[28:31]
    buffer_load_dwordx4 v[196:199], v2, s[4:7], s55 offen offset:2304 nt
L_cvx:
    s_sub_u32 s63, s63, 1
    s_cmp_lg_u32 s63, 0
    s_cbranch_scc1 L_top
    s_waitcnt lgkmcnt(0)
    s_sub_u32 s48, s60, s100
    s_add_u32 s100, s100, 207
    s_sub_u32 s49, s60, s62
    s_add_u32 s62, s62, 222
    s_cmp_ge_i32 s48, 0
    s_cbranch_scc1 L_cl0
    s_waitcnt vmcnt(11)
    v_mfma_f32_16x16x32_bf16 v[20:23], v[72:75], v[40:43], 0
    s_add_u32 s55, s47, 0
    buffer_load_dwordx4 v[72:75], v3, s[8:11], s55 offen offset:0 nt
    s_waitcnt vmcnt(11)
    v_mfma_f32_16x16x32_bf16 v[20:23], v[76:79], v[44:47], v[20:23]
    buffer_load_dwordx4 v[76:79], v3, s[8:11], s55 offen offset:256 nt
    s_waitcnt vmcnt(11)
    v_mfma_f32_16x16x32_bf16 v[20:23], v[80:83], v[48:51], v[20:23]
    buffer_load_dwordx4 v[80:83], v3, s[8:11], s55 offen offset:2048 nt
    s_waitcnt vmcnt(11)
    v_mfma_f32_16x16x32_bf16 v[20:23], v[84:87], v[52:55], v[20:23]
    buffer_load_dwordx4 v[84:87], v3, s[8:11], s55 offen offset:2304 nt
    s_waitcnt vmcnt(11)
    v_mfma_f32_16x16x32_bf16 v[20:23], v[88:91], v[56:59], v[20:23]
    buffer_load_dwordx4 v[88:91], v4, s[8:11], s55 offen offset:0 nt
    s_waitcnt vmcnt(11)
    v_mfma_f32_16x16x32_bf16 v[20:23], v[92:95], v[60:63], v[20:23]
    buffer_load_dwordx4 v[92:95], v4, s[8:11], s55 offen offset:256 nt
    s_waitcnt vmcnt(11)
    v_mfma_f32_16x16x32_bf16 v[20:23], v[96:99], v[64:67], v[20:23]
    buffer_load_dwordx4 v[96:99], v4, s[8:11], s55 offen offset:2048 nt
    s_waitcnt vmcnt(11)
    v_mfma_f32_16x16x32_bf16 v[20:23], v[100:103], v[68:71], v[20:23]
    buffer_load_dwordx4 v[100:103], v4, s[8:11], s55 offen offset:2304 nt
    s_waitcnt vmcnt(11)
    v_mfma_f32_16x16x32_bf16 v[32:35], v[104:107], v[40:43], 0
    s_add_u32 s55, s47, 32768
    buffer_load_dwordx4 v[104:107], v3, s[8:11], s55 offen offset:0 nt
    s_waitcnt vmcnt(11)
    v_mfma_f32_16x16x32_bf16 v[32:35], v[108:111], v[44:47], v[32:35]
    buffer_load_dwordx4 v[108:111], v3, s[8:11], s55 offen offset:256 nt
    s_waitcnt vmcnt(11)
    v_mfma_f32_16x16x32_bf16 v[32:35], v[112:115], v[48:51], v[32:35]
    buffer_load_dwordx4 v[112:115], v3, s[8:11], s55 offen offset:2048 nt
    v_mov_b32_dpp v11, v20 quad_perm:[0,0,0,0] row_mask:0xf bank_mask:0xf
    v_mov_b32_dpp v12, v21 quad_perm:[1,1,1,1] row_mask:0xf bank_mask:0xf
    v_mov_b32_dpp v13, v22 quad_perm:[2,2,2,2] row_mask:0xf bank_mask:0xf
    v_mov_b32_dpp v14, v23 quad_perm:[3,3,3,3] row_mask:0xf bank_mask:0xf
    s_waitcnt vmcnt(11)
    v_mfma_f32_16x16x32_bf16 v[32:35], v[116:119], v[52:55], v[32:35]
    buffer_load_dwordx4 v[116:119], v3, s[8:11], s55 offen offset:2304 nt
    v_add_f32 v11, v11, v12
    v_add_f32 v13, v13, v14
    v_add_f32 v11, v11, v13
    s_waitcnt vmcnt(11)
    v_mfma_f32_16x16x32_bf16 v[32:35], v[120:123], v[56:59], v[32:35]
    buffer_load_dwordx4 v[120:123], v4, s[8:11], s55 offen offset:0 nt
    v_cvt_pk_bf16_f32 v11, v11, v11
    v_and_b32 v11, 0xffff0000, v11
    v_mul_f32 v204, s51, v11
    s_waitcnt vmcnt(11)
    v_mfma_f32_16x16x32_bf16 v[32:35], v[124:127], v[60:63], v[32:35]
    buffer_load_dwordx4 v[124:127], v4, s[8:11], s55 offen offset:256 nt
    s_waitcnt vmcnt(11)
    v_mfma_f32_16x16x32_bf16 v[32:35], v[128:131], v[64:67], v[32:35]
    buffer_load_dwordx4 v[128:131], v4, s[8:11], s55 offen offset:2048 nt
    s_waitcnt vmcnt(11)
    v_mfma_f32_16x16x32_bf16 v[32:35], v[132:135], v[68:71], v[32:35]
    buffer_load_dwordx4 v[132:135], v4, s[8:11], s55 offen offset:2304 nt
    s_waitcnt vmcnt(11)
    v_mfma_f32_16x16x32_bf16 v[20:23], v[136:139], v[40:43], 0
    s_add_u32 s55, s47, 65536
    buffer_load_dwordx4 v[136:139], v3, s[8:11], s55 offen offset:0 nt
    s_waitcnt vmcnt(11)
    v_mfma_f32_16x16x32_bf16 v[20:23], v[140:143], v[44:47], v[20:23]
    buffer_load_dwordx4 v[140:143], v3, s[8:11], s55 offen offset:256 nt
    s_waitcnt vmcnt(11)
    v_mfma_f32_16x16x32_bf16 v[20:23], v[144:147], v[48:51], v[20:23]
    buffer_load_dwordx4 v[144:147], v3, s[8:11], s55 offen offset:2048 nt
    v_mov_b32_dpp v11, v32 quad_perm:[0,0,0,0] row_mask:0xf bank_mask:0xf
    v_mov_b32_dpp v12, v33 quad_perm:[1,1,1,1] row_mask:0xf bank_mask:0xf
    v_mov_b32_dpp v13, v34 quad_perm:[2,2,2,2] row_mask:0xf bank_mask:0xf
    v_mov_b32_dpp v14, v35 quad_perm:[3,3,3,3] row_mask:0xf bank_mask:0xf
    s_waitcnt vmcnt(11)
    v_mfma_f32_16x16x32_bf16 v[20:23], v[148:151], v[52:55], v[20:23]
    buffer_load_dwordx4 v[148:151], v3, s[8:11], s55 offen offset:2304 nt
    v_add_f32 v11, v11, v12
    v_add_f32 v13, v13, v14
    v_add_f32 v11, v11, v13
    s_waitcnt vmcnt(11)
    v_mfma_f32_16x16x32_bf16 v[20:23], v[152:155], v[56:59], v[20:23]
    buffer_load_dwordx4 v[152:155], v4, s[8:11], s55 offen offset:0 nt
    v_cvt_pk_bf16_f32 v11, v11, v11
    v_and_b32 v11, 0xffff0000, v11
    v_mul_f32 v205, s51, v11
    s_waitcnt vmcnt(11)
    v_mfma_f32_16x16x32_bf16 v[20:23], v[156:159], v[60:63], v[20:23]
    buffer_load_dwordx4 v[156:159], v4, s[8:11], s55 offen offset:256 nt
    s_waitcnt vmcnt(11)
    v_mfma_f32_16x16x32_bf16 v[20:23], v[160:163], v[64:67], v[20:23]
    buffer_load_dwordx4 v[160:163], v4, s[8:11], s55 offen offset:2048 nt
    s_waitcnt vmcnt(11)
    v_mfma_f32_16x16x32_bf16 v[20:23], v[164:167], v[68:71], v[20:23]
    buffer_load_dwordx4 v[164:167], v4, s[8:11], s55 offen offset:2304 nt
    s_waitcnt vmcnt(11)
    v_mfma_f32_16x16x32_bf16 v[32:35], v[168:171], v[40:43], 0
    s_add_u32 s55, s47, 98304
    buffer_load_dwordx4 v[168:171], v3, s[8:11], s55 offen offset:0 nt
    s_waitcnt vmcnt(11)
    v_mfma_f32_16x16x32_bf16 v[32:35], v[172:175], v[44:47], v[32:35]
    buffer_load_dwordx4 v[172:175], v3, s[8:11], s55 offen offset:256 nt
    s_waitcnt vmcnt(11)
    v_mfma_f32_16x16x32_bf16 v[32:35], v[176:179], v[48:51], v[32:35]
    buffer_load_dwordx4 v[176:179], v3, s[8:11], s55 offen offset:2048 nt
    v_mov_b32_dpp v11, v20 quad_perm:[0,0,0,0] row_mask:0xf bank_mask:0xf
    v_mov_b32_dpp v12, v21 quad_perm:[1,1,1,1] row_mask:0xf bank_mask:0xf
    v_mov_b32_dpp v13, v22 quad_perm:[2,2,2,2] row_mask:0xf bank_mask:0xf
    v_mov_b32_dpp v14, v23 quad_perm:[3,3,3,3] row_mask:0xf bank_mask:0xf
    s_waitcnt vmcnt(11)
    v_mfma_f32_16x16x32_bf16 v[32:35], v[180:183], v[52:55], v[32:35]
    buffer_load_dwordx4 v[180:183], v3, s[8:11], s55 offen offset:2304 nt
    v_add_f32 v11, v11, v12
    v_add_f32 v13, v13, v14
    v_add_f32 v11, v11, v13
    s_waitcnt vmcnt(11)
    v_mfma_f32_16x16x32_bf16 v[32:35], v[184:187], v[56:59], v[32:35]
    v_cvt_pk_bf16_f32 v11, v11, v11
    v_and_b32 v11, 0xffff0000, v11
    v_mul_f32 v206, s51, v11
    s_waitcnt vmcnt(11)
    v_mfma_f32_16x16x32_bf16 v[32:35], v[188:191], v[60:63], v[32:35]
    s_waitcnt vmcnt(11)
    v_mfma_f32_16x16x32_bf16 v[32:35], v[192:195], v[64:67], v[32:35]
    s_waitcnt vmcnt(11)
    v_mfma_f32_16x16x32_bf16 v[32:35], v[196:199], v[68:71], v[32:35]
    s_waitcnt vmcnt(11)
    buffer_load_dwordx4 v[184:187], v4, s[8:11], s55 offen offset:0 nt
    s_nop 5
    v_mov_b32_dpp v11, v32 quad_perm:[0,0,0,0] row_mask:0xf bank_mask:0xf
    v_mov_b32_dpp v12, v33 quad_perm:[1,1,1,1] row_mask:0xf bank_mask:0xf
    v_mov_b32_dpp v13, v34 quad_perm:[2,2,2,2] row_mask:0xf bank_mask:0xf
    v_mov_b32_dpp v14, v35 quad_perm:[3,3,3,3] row_mask:0xf bank_mask:0xf
    v_add_f32 v11, v11, v12
    v_add_f32 v13, v13, v14
    v_add_f32 v11, v11, v13
    v_cvt_pk_bf16_f32 v11, v11, v11
    v_and_b32 v11, 0xffff0000, v11
    v_mul_f32 v207, s51, v11
    v_max3_f32 v12, v204, v205, v206
    v_max_f32 v12, v12, v207
    s_nop 1
    v_max_f32_dpp v12, v12, v12 row_ror:4 row_mask:0xf bank_mask:0xf
    s_nop 1
    v_max_f32_dpp v12, v12, v12 row_ror:8 row_mask:0xf bank_mask:0xf
    v_mov_b32 v13, v12
    s_nop 1
    v_permlane16_swap_b32 v12, v13
    v_max_f32 v12, v12, v13
    s_waitcnt vmcnt(11)
    buffer_load_dwordx4 v[188:191], v4, s[8:11], s55 offen offset:256 nt
    v_mov_b32 v13, v12
    s_nop 1
    v_permlane32_swap_b32 v12, v13
    v_max_f32 v12, v12, v13
    v_max_f32 v12, v12, v9
    v_sub_f32 v13, v9, v12
    v_sub_f32 v204, v204, v12
    v_sub_f32 v205, v205, v12
    v_sub_f32 v206, v206, v12
    v_sub_f32 v207, v207, v12
    v_exp_f32 v13, v13
    v_exp_f32 v204, v204
    v_exp_f32 v205, v205
    v_exp_f32 v206, v206
    v_exp_f32 v207, v207
    v_mov_b32 v9, v12
    s_waitcnt vmcnt(11)
    buffer_load_dwordx4 v[192:195], v4, s[8:11], s55 offen offset:2048 nt
    v_fma_f32 v10, v10, v13, v204
    v_pk_mul_f32 v[24:25], v[24:25], v[12:13] op_sel:[0,1] op_sel_hi:[1,1]
    v_pk_mul_f32 v[26:27], v[26:27], v[12:13] op_sel:[0,1] op_sel_hi:[1,1]
    v_pk_mul_f32 v[28:29], v[28:29], v[12:13] op_sel:[0,1] op_sel_hi:[1,1]
    v_pk_mul_f32 v[30:31], v[30:31], v[12:13] op_sel:[0,1] op_sel_hi:[1,1]
    v_add_f32 v10, v10, v205
    v_add_f32 v10, v10, v206
    v_add_f32 v10, v10, v207
    v_cvt_pk_bf16_f32 v204, v204, v204
    v_cvt_pk_bf16_f32 v205, v205, v205
    v_cvt_pk_bf16_f32 v206, v206, v206
    v_cvt_pk_bf16_f32 v207, v207, v207
    s_waitcnt vmcnt(11)
    buffer_load_dwordx4 v[196:199], v4, s[8:11], s55 offen offset:2304 nt
    s_and_b32 s48, s3, 1
    s_lshl_b32 s48, s48, 2
    v_mov_b32 v11, s48
    v_mov_b32 v12, 1
    s_mov_b64 exec, 1
    ds_add_u32 v11, v12 offset:560
    s_mov_b64 exec, -1
    v_add_f32_dpp v10, v10, v10 row_ror:8 row_mask:0xf bank_mask:0xf
    s_nop 1
    v_add_f32_dpp v10, v10, v10 row_ror:4 row_mask:0xf bank_mask:0xf
    s_nop 1
    v_add_f32_dpp v10, v10, v10 row_ror:2 row_mask:0xf bank_mask:0xf
    s_nop 1
    v_add_f32_dpp v10, v10, v10 row_ror:1 row_mask:0xf bank_mask:0xf
    v_mov_b32 v11, v10
    s_nop 1
    v_permlane16_swap_b32 v10, v11
    v_add_f32 v10, v10, v11
    v_mov_b32 v11, v10
    s_nop 1
    v_permlane32_swap_b32 v10, v11
    v_add_f32 v10, v10, v11
    v_mul_f32 v10, 0.25, v10
    v_and_b32 v11, 15, v0
    v_lshrrev_b32 v12, 4, v0
    v_lshlrev_b32 v13, 4, v0
    s_lshl_b32 s48, s3, 10
    v_add_u32 v15, s48, v13
    s_lshl_b32 s48, s3, 3
    v_mov_b32 v18, s48
    v_mov_b32 v16, v9
    v_mov_b32 v17, v10
    ds_write_b64 v18, v[16:17] offset:576
    v_mov_b32 v18, 0
    v_mov_b32 v19, 1
    s_branch L_clx
L_cl0:
    s_waitcnt vmcnt(23)
    v_mfma_f32_16x16x32_bf16 v[20:23], v[72:75], v[40:43], 0
    s_add_u32 s55, s47, 0
    buffer_load_dwordx4 v[72:75], v3, s[8:11], s55 offen offset:0 nt
    s_waitcnt vmcnt(23)
    v_mfma_f32_16x16x32_bf16 v[20:23], v[76:79], v[44:47], v[20:23]
    buffer_load_dwordx4 v[76:79], v3, s[8:11], s55 offen offset:256 nt
    s_waitcnt vmcnt(23)
    v_mfma_f32_16x16x32_bf16 v[20:23], v[80:83], v[48:51], v[20:23]
    buffer_load_dwordx4 v[80:83], v3, s[8:11], s55 offen offset:2048 nt
    s_waitcnt vmcnt(23)
    v_mfma_f32_16x16x32_bf16 v[20:23], v[84:87], v[52:55], v[20:23]
    buffer_load_dwordx4 v[84:87], v3, s[8:11], s55 offen offset:2304 nt
    s_waitcnt vmcnt(23)
    v_mfma_f32_16x16x32_bf16 v[20:23], v[88:91], v[56:59], v[20:23]
    buffer_load_dwordx4 v[88:91], v4, s[8:11], s55 offen offset:0 nt
    s_waitcnt vmcnt(23)
    v_mfma_f32_16x16x32_bf16 v[20:23], v[92:95], v[60:63], v[20:23]
    buffer_load_dwordx4 v[92:95], v4, s[8:11], s55 offen offset:256 nt
    s_waitcnt vmcnt(23)
    v_mfma_f32_16x16x32_bf16 v[20:23], v[96:99], v[64:67], v[20:23]
    buffer_load_dwordx4 v[96:99], v4, s[8:11], s55 offen offset:2048 nt
    s_waitcnt vmcnt(23)
    v_mfma_f32_16x16x32_bf16 v[20:23], v[100:103], v[68:71], v[20:23]
    buffer_load_dwordx4 v[100:103], v4, s[8:11], s55 offen offset:2304 nt
    s_waitcnt vmcnt(23)
    v_mfma_f32_16x16x32_bf16 v[32:35], v[104:107], v[40:43], 0
    s_add_u32 s55, s47, 32768
    buffer_load_dwordx4 v[104:107], v3, s[8:11], s55 offen offset:0 nt
    s_waitcnt vmcnt(23)
    v_mfma_f32_16x16x32_bf16 v[32:35], v[108:111], v[44:47], v[32:35]
    buffer_load_dwordx4 v[108:111], v3, s[8:11], s55 offen offset:256 nt
    s_waitcnt vmcnt(23)
    v_mfma_f32_16x16x32_bf16 v[32:35], v[112:115], v[48:51], v[32:35]
    buffer_load_dwordx4 v[112:115], v3, s[8:11], s55 offen offset:2048 nt
    v_mov_b32_dpp v11, v20 quad_perm:[0,0,0,0] row_mask:0xf bank_mask:0xf
    v_mov_b32_dpp v12, v21 quad_perm:[1,1,1,1] row_mask:0xf bank_mask:0xf
    v_mov_b32_dpp v13, v22 quad_perm:[2,2,2,2] row_mask:0xf bank_mask:0xf
    v_mov_b32_dpp v14, v23 quad_perm:[3,3,3,3] row_mask:0xf bank_mask:0xf
    s_waitcnt vmcnt(23)
    v_mfma_f32_16x16x32_bf16 v[32:35], v[116:119], v[52:55], v[32:35]
    buffer_load_dwordx4 v[116:119], v3, s[8:11], s55 offen offset:2304 nt
    v_add_f32 v11, v11, v12
    v_add_f32 v13, v13, v14
    v_add_f32 v11, v11, v13
    s_waitcnt vmcnt(23)
    v_mfma_f32_16x16x32_bf16 v[32:35], v[120:123], v[56:59], v[32:35]
    buffer_load_dwordx4 v[120:123], v4, s[8:11], s55 offen offset:0 nt
    v_cvt_pk_bf16_f32 v11, v11, v11
    v_and_b32 v11, 0xffff0000, v11
    v_mul_f32 v204, s51, v11
    s_waitcnt vmcnt(23)
    v_mfma_f32_16x16x32_bf16 v[32:35], v[124:127], v[60:63], v[32:35]
    buffer_load_dwordx4 v[124:127], v4, s[8:11], s55 offen offset:256 nt
    s_waitcnt vmcnt(23)
    v_mfma_f32_16x16x32_bf16 v[32:35], v[128:131], v[64:67], v[32:35]
    buffer_load_dwordx4 v[128:131], v4, s[8:11], s55 offen offset:2048 nt
    s_waitcnt vmcnt(23)
    v_mfma_f32_16x16x32_bf16 v[32:35], v[132:135], v[68:71], v[32:35]
    buffer_load_dwordx4 v[132:135], v4, s[8:11], s55 offen offset:2304 nt
    s_waitcnt vmcnt(23)
    v_mfma_f32_16x16x32_bf16 v[20:23], v[136:139], v[40:43], 0
    s_add_u32 s55, s47, 65536
    buffer_load_dwordx4 v[136:139], v3, s[8:11], s55 offen offset:0 nt
    s_waitcnt vmcnt(23)
    v_mfma_f32_16x16x32_bf16 v[20:23], v[140:143], v[44:47], v[20:23]
    buffer_load_dwordx4 v[140:143], v3, s[8:11], s55 offen offset:256 nt
    s_waitcnt vmcnt(23)
    v_mfma_f32_16x16x32_bf16 v[20:23], v[144:147], v[48:51], v[20:23]
    buffer_load_dwordx4 v[144:147], v3, s[8:11], s55 offen offset:2048 nt
    v_mov_b32_dpp v11, v32 quad_perm:[0,0,0,0] row_mask:0xf bank_mask:0xf
    v_mov_b32_dpp v12, v33 quad_perm:[1,1,1,1] row_mask:0xf bank_mask:0xf
    v_mov_b32_dpp v13, v34 quad_perm:[2,2,2,2] row_mask:0xf bank_mask:0xf
    v_mov_b32_dpp v14, v35 quad_perm:[3,3,3,3] row_mask:0xf bank_mask:0xf
    s_waitcnt vmcnt(23)
    v_mfma_f32_16x16x32_bf16 v[20:23], v[148:151], v[52:55], v[20:23]
    buffer_load_dwordx4 v[148:151], v3, s[8:11], s55 offen offset:2304 nt
    v_add_f32 v11, v11, v12
    v_add_f32 v13, v13, v14
    v_add_f32 v11, v11, v13
    s_waitcnt vmcnt(23)
    v_mfma_f32_16x16x32_bf16 v[20:23], v[152:155], v[56:59], v[20:23]
    buffer_load_dwordx4 v[152:155], v4, s[8:11], s55 offen offset:0 nt
    v_cvt_pk_bf16_f32 v11, v11, v11
    v_and_b32 v11, 0xffff0000, v11
    v_mul_f32 v205, s51, v11
    s_waitcnt vmcnt(23)
    v_mfma_f32_16x16x32_bf16 v[20:23], v[156:159], v[60:63], v[20:23]
    buffer_load_dwordx4 v[156:159], v4, s[8:11], s55 offen offset:256 nt
    s_waitcnt vmcnt(23)
    v_mfma_f32_16x16x32_bf16 v[20:23], v[160:163], v[64:67], v[20:23]
    buffer_load_dwordx4 v[160:163], v4, s[8:11], s55 offen offset:2048 nt
    s_waitcnt vmcnt(23)
    v_mfma_f32_16x16x32_bf16 v[20:23], v[164:167], v[68:71], v[20:23]
    buffer_load_dwordx4 v[164:167], v4, s[8:11], s55 offen offset:2304 nt
    s_waitcnt vmcnt(23)
    v_mfma_f32_16x16x32_bf16 v[32:35], v[168:171], v[40:43], 0
    s_add_u32 s55, s47, 98304
    buffer_load_dwordx4 v[168:171], v3, s[8:11], s55 offen offset:0 nt
    s_waitcnt vmcnt(23)
    v_mfma_f32_16x16x32_bf16 v[32:35], v[172:175], v[44:47], v[32:35]
    buffer_load_dwordx4 v[172:175], v3, s[8:11], s55 offen offset:256 nt
    s_waitcnt vmcnt(23)
    v_mfma_f32_16x16x32_bf16 v[32:35], v[176:179], v[48:51], v[32:35]
    buffer_load_dwordx4 v[176:179], v3, s[8:11], s55 offen offset:2048 nt
    v_mov_b32_dpp v11, v20 quad_perm:[0,0,0,0] row_mask:0xf bank_mask:0xf
    v_mov_b32_dpp v12, v21 quad_perm:[1,1,1,1] row_mask:0xf bank_mask:0xf
    v_mov_b32_dpp v13, v22 quad_perm:[2,2,2,2] row_mask:0xf bank_mask:0xf
    v_mov_b32_dpp v14, v23 quad_perm:[3,3,3,3] row_mask:0xf bank_mask:0xf
    s_waitcnt vmcnt(23)
    v_mfma_f32_16x16x32_bf16 v[32:35], v[180:183], v[52:55], v[32:35]
    buffer_load_dwordx4 v[180:183], v3, s[8:11], s55 offen offset:2304 nt
    v_add_f32 v11, v11, v12
    v_add_f32 v13, v13, v14
    v_add_f32 v11, v11, v13
    s_waitcnt vmcnt(23)
    v_mfma_f32_16x16x32_bf16 v[32:35], v[184:187], v[56:59], v[32:35]
    v_cvt_pk_bf16_f32 v11, v11, v11
    v_and_b32 v11, 0xffff0000, v11
    v_mul_f32 v206, s51, v11
    s_waitcnt vmcnt(23)
    v_mfma_f32_16x16x32_bf16 v[32:35], v[188:191], v[60:63], v[32:35]
    s_waitcnt vmcnt(23)
    v_mfma_f32_16x16x32_bf16 v[32:35], v[192:195], v[64:67], v[32:35]
    s_waitcnt vmcnt(23)
    v_mfma_f32_16x16x32_bf16 v[32:35], v[196:199], v[68:71], v[32:35]
    s_waitcnt vmcnt(23)
    buffer_load_dwordx4 v[184:187], v4, s[8:11], s55 offen offset:0 nt
    s_nop 5
    v_mov_b32_dpp v11, v32 quad_perm:[0,0,0,0] row_mask:0xf bank_mask:0xf
    v_mov_b32_dpp v12, v33 quad_perm:[1,1,1,1] row_mask:0xf bank_mask:0xf
    v_mov_b32_dpp v13, v34 quad_perm:[2,2,2,2] row_mask:0xf bank_mask:0xf
    v_mov_b32_dpp v14, v35 quad_perm:[3,3,3,3] row_mask:0xf bank_mask:0xf
    v_add_f32 v11, v11, v12
    v_add_f32 v13, v13, v14
    v_add_f32 v11, v11, v13
    v_cvt_pk_bf16_f32 v11, v11, v11
    v_and_b32 v11, 0xffff0000, v11
    v_mul_f32 v207, s51, v11
    v_max3_f32 v12, v204, v205, v206
    v_max_f32 v12, v12, v207
    s_nop 1
    v_max_f32_dpp v12, v12, v12 row_ror:4 row_mask:0xf bank_mask:0xf
    s_nop 1
    v_max_f32_dpp v12, v12, v12 row_ror:8 row_mask:0xf bank_mask:0xf
    v_mov_b32 v13, v12
    s_nop 1
    v_permlane16_swap_b32 v12, v13
    v_max_f32 v12, v12, v13
    s_waitcnt vmcnt(23)
    buffer_load_dwordx4 v[188:191], v4, s[8:11], s55 offen offset:256 nt
    v_mov_b32 v13, v12
    s_nop 1
    v_permlane32_swap_b32 v12, v13
    v_max_f32 v12, v12, v13
    v_max_f32 v12, v12, v9
    v_sub_f32 v13, v9, v12
    v_sub_f32 v204, v204, v12
    v_sub_f32 v205, v205, v12
    v_sub_f32 v206, v206, v12
    v_sub_f32 v207, v207, v12
    v_exp_f32 v13, v13
    v_exp_f32 v204, v204
    v_exp_f32 v205, v205
    v_exp_f32 v206, v206
    v_exp_f32 v207, v207
    v_mov_b32 v9, v12
    s_waitcnt vmcnt(23)
    buffer_load_dwordx4 v[192:195], v4, s[8:11], s55 offen offset:2048 nt
    v_fma_f32 v10, v10, v13, v204
    v_pk_mul_f32 v[24:25], v[24:25], v[12:13] op_sel:[0,1] op_sel_hi:[1,1]
    v_pk_mul_f32 v[26:27], v[26:27], v[12:13] op_sel:[0,1] op_sel_hi:[1,1]
    v_pk_mul_f32 v[28:29], v[28:29], v[12:13] op_sel:[0,1] op_sel_hi:[1,1]
    v_pk_mul_f32 v[30:31], v[30:31], v[12:13] op_sel:[0,1] op_sel_hi:[1,1]
    v_add_f32 v10, v10, v205
    v_add_f32 v10, v10, v206
    v_add_f32 v10, v10, v207
    v_cvt_pk_bf16_f32 v204, v204, v204
    v_cvt_pk_bf16_f32 v205, v205, v205
    v_cvt_pk_bf16_f32 v206, v206, v206
    v_cvt_pk_bf16_f32 v207, v207, v207
    s_waitcnt vmcnt(23)
    buffer_load_dwordx4 v[196:199], v4, s[8:11], s55 offen offset:2304 nt
    s_and_b32 s48, s3, 1
    s_lshl_b32 s48, s48, 2
    v_mov_b32 v11, s48
    v_mov_b32 v12, 1
    s_mov_b64 exec, 1
    ds_add_u32 v11, v12 offset:560
    s_mov_b64 exec, -1
    v_add_f32_dpp v10, v10, v10 row_ror:8 row_mask:0xf bank_mask:0xf
    s_nop 1
    v_add_f32_dpp v10, v10, v10 row_ror:4 row_mask:0xf bank_mask:0xf
    s_nop 1
    v_add_f32_dpp v10, v10, v10 row_ror:2 row_mask:0xf bank_mask:0xf
    s_nop 1
    v_add_f32_dpp v10, v10, v10 row_ror:1 row_mask:0xf bank_mask:0xf
    v_mov_b32 v11, v10
    s_nop 1
    v_permlane16_swap_b32 v10, v11
    v_add_f32 v10, v10, v11
    v_mov_b32 v11, v10
    s_nop 1
    v_permlane32_swap_b32 v10, v11
    v_add_f32 v10, v10, v11
    v_mul_f32 v10, 0.25, v10
    v_and_b32 v11, 15, v0
    v_lshrrev_b32 v12, 4, v0
    v_lshlrev_b32 v13, 4, v0
    s_lshl_b32 s48, s3, 10
    v_add_u32 v15, s48, v13
    s_lshl_b32 s48, s3, 3
    v_mov_b32 v18, s48
    v_mov_b32 v16, v9
    v_mov_b32 v17, v10
    ds_write_b64 v18, v[16:17] offset:576
    v_mov_b32 v18, 0
    v_mov_b32 v19, 1
L_clx:
    v_and_b32_dpp v32, v204, v5 row_newbcast:0 row_mask:0xf bank_mask:0xf
    v_and_b32_dpp v33, v204, v6 row_newbcast:0 row_mask:0xf bank_mask:0xf
    v_and_b32_dpp v34, v204, v7 row_newbcast:0 row_mask:0xf bank_mask:0xf
    v_and_b32_dpp v35, v204, v8 row_newbcast:0 row_mask:0xf bank_mask:0xf
    s_nop 1
    v_mfma_f32_16x16x32_bf16 v[24:27], v[32:35], v[72:75], v[24:27]
    v_mfma_f32_16x16x32_bf16 v[28:31], v[32:35], v[76:79], v[28:31]
    v_and_b32_dpp v36, v204, v5 row_newbcast:4 row_mask:0xf bank_mask:0xf
    v_and_b32_dpp v37, v204, v6 row_newbcast:4 row_mask:0xf bank_mask:0xf
    v_and_b32_dpp v38, v204, v7 row_newbcast:4 row_mask:0xf bank_mask:0xf
    v_and_b32_dpp v39, v204, v8 row_newbcast:4 row_mask:0xf bank_mask:0xf
    s_nop 1
    v_mfma_f32_16x16x32_bf16 v[24:27], v[36:39], v[80:83], v[24:27]
    v_mfma_f32_16x16x32_bf16 v[28:31], v[36:39], v[84:87], v[28:31]
    v_and_b32_dpp v32, v204, v5 row_newbcast:8 row_mask:0xf bank_mask:0xf
    v_and_b32_dpp v33, v204, v6 row_newbcast:8 row_mask:0xf bank_mask:0xf
    v_and_b32_dpp v34, v204, v7 row_newbcast:8 row_mask:0xf bank_mask:0xf
    v_and_b32_dpp v35, v204, v8 row_newbcast:8 row_mask:0xf bank_mask:0xf
    s_nop 1
    v_mfma_f32_16x16x32_bf16 v[24:27], v[32:35], v[88:91], v[24:27]
    v_mfma_f32_16x16x32_bf16 v[28:31], v[32:35], v[92:95], v[28:31]
    v_and_b32_dpp v36, v204, v5 row_newbcast:12 row_mask:0xf bank_mask:0xf
    v_and_b32_dpp v37, v204, v6 row_newbcast:12 row_mask:0xf bank_mask:0xf
    v_and_b32_dpp v38, v204, v7 row_newbcast:12 row_mask:0xf bank_mask:0xf
    v_and_b32_dpp v39, v204, v8 row_newbcast:12 row_mask:0xf bank_mask:0xf
    s_nop 1
    v_mfma_f32_16x16x32_bf16 v[24:27], v[36:39], v[96:99], v[24:27]
    v_mfma_f32_16x16x32_bf16 v[28:31], v[36:39], v[100:103], v[28:31]
    v_and_b32_dpp v32, v205, v5 row_newbcast:0 row_mask:0xf bank_mask:0xf
    v_and_b32_dpp v33, v205, v6 row_newbcast:0 row_mask:0xf bank_mask:0xf
    v_and_b32_dpp v34, v205, v7 row_newbcast:0 row_mask:0xf bank_mask:0xf
    v_and_b32_dpp v35, v205, v8 row_newbcast:0 row_mask:0xf bank_mask:0xf
    s_waitcnt vmcnt(23)
    s_nop 0
    v_mfma_f32_16x16x32_bf16 v[24:27], v[32:35], v[104:107], v[24:27]
    s_waitcnt vmcnt(22)
    v_mfma_f32_16x16x32_bf16 v[28:31], v[32:35], v[108:111], v[28:31]
    v_and_b32_dpp v36, v205, v5 row_newbcast:4 row_mask:0xf bank_mask:0xf
    v_and_b32_dpp v37, v205, v6 row_newbcast:4 row_mask:0xf bank_mask:0xf
    v_and_b32_dpp v38, v205, v7 row_newbcast:4 row_mask:0xf bank_mask:0xf
    v_and_b32_dpp v39, v205, v8 row_newbcast:4 row_mask:0xf bank_mask:0xf
    s_waitcnt vmcnt(21)
    s_nop 0
    v_mfma_f32_16x16x32_bf16 v[24:27], v[36:39], v[112:115], v[24:27]
    s_waitcnt vmcnt(20)
    v_mfma_f32_16x16x32_bf16 v[28:31], v[36:39], v[116:119], v[28:31]
    v_and_b32_dpp v32, v205, v5 row_newbcast:8 row_mask:0xf bank_mask:0xf
    v_and_b32_dpp v33, v205, v6 row_newbcast:8 row_mask:0xf bank_mask:0xf
    v_and_b32_dpp v34, v205, v7 row_newbcast:8 row_mask:0xf bank_mask:0xf
    v_and_b32_dpp v35, v205, v8 row_newbcast:8 row_mask:0xf bank_mask:0xf
    s_waitcnt vmcnt(19)
    s_nop 0
    v_mfma_f32_16x16x32_bf16 v[24:27], v[32:35], v[120:123], v[24:27]
    s_waitcnt vmcnt(18)
    v_mfma_f32_16x16x32_bf16 v[28:31], v[32:35], v[124:127], v[28:31]
    v_and_b32_dpp v36, v205, v5 row_newbcast:12 row_mask:0xf bank_mask:0xf
    v_and_b32_dpp v37, v205, v6 row_newbcast:12 row_mask:0xf bank_mask:0xf
    v_and_b32_dpp v38, v205, v7 row_newbcast:12 row_mask:0xf bank_mask:0xf
    v_and_b32_dpp v39, v205, v8 row_newbcast:12 row_mask:0xf bank_mask:0xf
    s_waitcnt vmcnt(17)
    s_nop 0
    v_mfma_f32_16x16x32_bf16 v[24:27], v[36:39], v[128:131], v[24:27]
    s_waitcnt vmcnt(16)
    v_mfma_f32_16x16x32_bf16 v[28:31], v[36:39], v[132:135], v[28:31]
    v_and_b32_dpp v32, v206, v5 row_newbcast:0 row_mask:0xf bank_mask:0xf
    v_and_b32_dpp v33, v206, v6 row_newbcast:0 row_mask:0xf bank_mask:0xf
    v_and_b32_dpp v34, v206, v7 row_newbcast:0 row_mask:0xf bank_mask:0xf
    v_and_b32_dpp v35, v206, v8 row_newbcast:0 row_mask:0xf bank_mask:0xf
    s_waitcnt vmcnt(15)
    s_nop 0
    v_mfma_f32_16x16x32_bf16 v[24:27], v[32:35], v[136:139], v[24:27]
    s_waitcnt vmcnt(14)
    v_mfma_f32_16x16x32_bf16 v[28:31], v[32:35], v[140:143], v[28:31]
    v_and_b32_dpp v36, v206, v5 row_newbcast:4 row_mask:0xf bank_mask:0xf
    v_and_b32_dpp v37, v206, v6 row_newbcast:4 row_mask:0xf bank_mask:0xf
    v_and_b32_dpp v38, v206, v7 row_newbcast:4 row_mask:0xf bank_mask:0xf
    v_and_b32_dpp v39, v206, v8 row_newbcast:4 row_mask:0xf bank_mask:0xf
    s_waitcnt vmcnt(13)
    s_nop 0
    v_mfma_f32_16x16x32_bf16 v[24:27], v[36:39], v[144:147], v[24:27]
    s_waitcnt vmcnt(12)
    v_mfma_f32_16x16x32_bf16 v[28:31], v[36:39], v[148:151], v[28:31]
    v_and_b32_dpp v32, v206, v5 row_newbcast:8 row_mask:0xf bank_mask:0xf
    v_and_b32_dpp v33, v206, v6 row_newbcast:8 row_mask:0xf bank_mask:0xf
    v_and_b32_dpp v34, v206, v7 row_newbcast:8 row_mask:0xf bank_mask:0xf
    v_and_b32_dpp v35, v206, v8 row_newbcast:8 row_mask:0xf bank_mask:0xf
    s_waitcnt vmcnt(11)
    s_nop 0
    v_mfma_f32_16x16x32_bf16 v[24:27], v[32:35], v[152:155], v[24:27]
    s_waitcnt vmcnt(10)
    v_mfma_f32_16x16x32_bf16 v[28:31], v[32:35], v[156:159], v[28:31]
    v_and_b32_dpp v36, v206, v5 row_newbcast:12 row_mask:0xf bank_mask:0xf
    v_and_b32_dpp v37, v206, v6 row_newbcast:12 row_mask:0xf bank_mask:0xf
    v_and_b32_dpp v38, v206, v7 row_newbcast:12 row_mask:0xf bank_mask:0xf
    v_and_b32_dpp v39, v206, v8 row_newbcast:12 row_mask:0xf bank_mask:0xf
    s_waitcnt vmcnt(9)
    s_nop 0
    v_mfma_f32_16x16x32_bf16 v[24:27], v[36:39], v[160:163], v[24:27]
    s_waitcnt vmcnt(8)
    v_mfma_f32_16x16x32_bf16 v[28:31], v[36:39], v[164:167], v[28:31]
    v_and_b32_dpp v32, v207, v5 row_newbcast:0 row_mask:0xf bank_mask:0xf
    v_and_b32_dpp v33, v207, v6 row_newbcast:0 row_mask:0xf bank_mask:0xf
    v_and_b32_dpp v34, v207, v7 row_newbcast:0 row_mask:0xf bank_mask:0xf
    v_and_b32_dpp v35, v207, v8 row_newbcast:0 row_mask:0xf bank_mask:0xf
    s_waitcnt vmcnt(7)
    s_nop 0
    v_mfma_f32_16x16x32_bf16 v[24:27], v[32:35], v[168:171], v[24:27]
    s_waitcnt vmcnt(6)
    v_mfma_f32_16x16x32_bf16 v[28:31], v[32:35], v[172:175], v[28:31]
    v_and_b32_dpp v36, v207, v5 row_newbcast:4 row_mask:0xf bank_mask:0xf
    v_and_b32_dpp v37, v207, v6 row_newbcast:4 row_mask:0xf bank_mask:0xf
    v_and_b32_dpp v38, v207, v7 row_newbcast:4 row_mask:0xf bank_mask:0xf
    v_and_b32_dpp v39, v207, v8 row_newbcast:4 row_mask:0xf bank_mask:0xf
    s_waitcnt vmcnt(5)
    s_nop 0
    v_mfma_f32_16x16x32_bf16 v[24:27], v[36:39], v[176:179], v[24:27]
    s_waitcnt vmcnt(4)
    v_mfma_f32_16x16x32_bf16 v[28:31], v[36:39], v[180:183], v[28:31]
    v_and_b32_dpp v32, v207, v5 row_newbcast:8 row_mask:0xf bank_mask:0xf
    v_and_b32_dpp v33, v207, v6 row_newbcast:8 row_mask:0xf bank_mask:0xf
    v_and_b32_dpp v34, v207, v7 row_newbcast:8 row_mask:0xf bank_mask:0xf
    v_and_b32_dpp v35, v207, v8 row_newbcast:8 row_mask:0xf bank_mask:0xf
    s_waitcnt vmcnt(3)
    s_nop 0
    v_mfma_f32_16x16x32_bf16 v[24:27], v[32:35], v[184:187], v[24:27]
    s_waitcnt vmcnt(2)
    v_mfma_f32_16x16x32_bf16 v[28:31], v[32:35], v[188:191], v[28:31]
    v_and_b32_dpp v36, v207, v5 row_newbcast:12 row_mask:0xf bank_mask:0xf
    v_and_b32_dpp v37, v207, v6 row_newbcast:12 row_mask:0xf bank_mask:0xf
    v_and_b32_dpp v38, v207, v7 row_newbcast:12 row_mask:0xf bank_mask:0xf
    v_and_b32_dpp v39, v207, v8 row_newbcast:12 row_mask:0xf bank_mask:0xf
    s_waitcnt vmcnt(1)
    s_nop 0
    v_mfma_f32_16x16x32_bf16 v[24:27], v[36:39], v[192:195], v[24:27]
    s_waitcnt vmcnt(0)
    v_mfma_f32_16x16x32_bf16 v[28:31], v[36:39], v[196:199], v[28:31]
L_sdone:
    s_mov_b32 exec_lo, 0
    s_mov_b32 s83, -1
    s_nop 5
    v_mov_b32 v24, v28
    v_mov_b32 v25, v29
    v_mov_b32 v26, v30
    v_mov_b32 v27, v31
    s_mov_b32 exec_lo, -1
    ds_write_b128 v15, v[24:27] offset:640
    s_cmp_lt_u32 s3, 2
    s_cbranch_scc1 L_cnt
    s_mov_b64 exec, 1
    ds_add_rtn_u32 v14, v18, v19 offset:552
    s_mov_b64 exec, -1
    s_waitcnt lgkmcnt(0)
    v_readfirstlane_b32 s48, v14
    s_nop 0
    s_cmp_lg_u32 s48, 0
    s_cbranch_scc1 L_nd
    s_mov_b32 s83, 0
    s_mov_b64 exec, 0
    s_branch L_merge
L_nd:
    s_cmp_lg_u32 s48, 5
    s_cbranch_scc1 L_b1
    ds_read_b128 v[104:107], v18 offset:592
    ds_read_b128 v[108:111], v18 offset:608
    ds_read_b128 v[112:115], v18 offset:624
    ds_read_b128 v[72:75], v13 offset:2688
    ds_read_b128 v[76:79], v13 offset:3712
    ds_read_b128 v[80:83], v13 offset:4736
    ds_read_b128 v[84:87], v13 offset:5760
    ds_read_b128 v[88:91], v13 offset:6784
    ds_read_b128 v[92:95], v13 offset:7808
    s_waitcnt lgkmcnt(6)
    v_max3_f32 v16, v104, v106, v108
    v_max3_f32 v17, v110, v112, v114
    v_max_f32 v16, v16, v17
    v_sub_f32 v104, v104, v16
    v_sub_f32 v106, v106, v16
    v_sub_f32 v108, v108, v16
    v_sub_f32 v110, v110, v16
    v_sub_f32 v112, v112, v16
    v_sub_f32 v114, v114, v16
    v_exp_f32 v104, v104
    v_exp_f32 v106, v106
    v_exp_f32 v108, v108
    v_exp_f32 v110, v110
    v_exp_f32 v112, v112
    v_exp_f32 v114, v114
    s_waitcnt lgkmcnt(0)
    v_pk_mul_f32 v[20:21], v[72:73], v[104:105] op_sel:[0,0] op_sel_hi:[1,0]
    v_pk_mul_f32 v[22:23], v[74:75], v[104:105] op_sel:[0,0] op_sel_hi:[1,0]
    v_pk_fma_f32 v[20:21], v[76:77], v[106:107], v[20:21] op_sel:[0,0,0] op_sel_hi:[1,0,1]
    v_pk_fma_f32 v[22:23], v[78:79], v[106:107], v[22:23] op_sel:[0,0,0] op_sel_hi:[1,0,1]
    v_pk_fma_f32 v[20:21], v[80:81], v[108:109], v[20:21] op_sel:[0,0,0] op_sel_hi:[1,0,1]
    v_pk_fma_f32 v[22:23], v[82:83], v[108:109], v[22:23] op_sel:[0,0,0] op_sel_hi:[1,0,1]
    v_pk_fma_f32 v[20:21], v[84:85], v[110:111], v[20:21] op_sel:[0,0,0] op_sel_hi:[1,0,1]
    v_pk_fma_f32 v[22:23], v[86:87], v[110:111], v[22:23] op_sel:[0,0,0] op_sel_hi:[1,0,1]
    v_pk_fma_f32 v[20:21], v[88:89], v[112:113], v[20:21] op_sel:[0,0,0] op_sel_hi:[1,0,1]
    v_pk_fma_f32 v[22:23], v[90:91], v[112:113], v[22:23] op_sel:[0,0,0] op_sel_hi:[1,0,1]
    v_pk_fma_f32 v[20:21], v[92:93], v[114:115], v[20:21] op_sel:[0,0,0] op_sel_hi:[1,0,1]
    v_pk_fma_f32 v[22:23], v[94:95], v[114:115], v[22:23] op_sel:[0,0,0] op_sel_hi:[1,0,1]
    v_mul_f32 v17, v105, v104
    v_fmac_f32 v17, v107, v106
    v_fmac_f32 v17, v109, v108
    v_fmac_f32 v17, v111, v110
    v_fmac_f32 v17, v113, v112
    v_fmac_f32 v17, v115, v114
    ds_write_b128 v13, v[20:23] offset:2688
    ds_write_b64 v18, v[16:17] offset:592
L_cnt:
    s_mov_b64 exec, 1
    ds_add_rtn_u32 v19, v18, v19 offset:544
    s_mov_b64 exec, -1
    ds_read_b128 v[104:107], v18 offset:576
    ds_read_b128 v[108:111], v18 offset:592
    ds_read_b128 v[72:75], v13 offset:640
    ds_read_b128 v[76:79], v13 offset:1664
    ds_read_b128 v[80:83], v13 offset:2688
    v_lshlrev_b32 v14, 5, v11
    v_and_b32 v15, 1, v12
    v_lshl_add_u32 v14, v15, 4, v14
    v_lshrrev_b32 v15, 1, v12
    v_lshl_add_u32 v14, v15, 9, v14
    s_waitcnt lgkmcnt(5)
    v_readfirstlane_b32 s48, v19
    s_nop 0
    s_cmp_eq_u32 s48, 2
    s_cbranch_scc1 L_merge
    s_waitcnt lgkmcnt(0)
    s_branch L_b1
L_merge:
    s_lshl_b32 s48, s2, 10
    s_add_u32 s48, s48, 0x20000
    s_lshl_b32 s49, s44, 4
    s_lshl_b32 s50, s43, 2
    s_add_u32 s49, s49, s50
    s_add_u32 s49, s49, s45
    s_lshl_b32 s49, s49, 4
    s_add_u32 s49, s49, 0x10000
    s_waitcnt lgkmcnt(3)
    v_max3_f32 v16, v104, v106, v108
    v_and_b32 v16, s101, v16
    v_sub_f32 v104, v104, v16
    v_sub_f32 v106, v106, v16
    v_sub_f32 v108, v108, v16
    v_exp_f32 v104, v104
    v_exp_f32 v106, v106
    v_exp_f32 v108, v108
    s_waitcnt lgkmcnt(0)
    v_pk_mul_f32 v[20:21], v[72:73], v[104:105] op_sel:[0,0] op_sel_hi:[1,0]
    v_pk_mul_f32 v[22:23], v[74:75], v[104:105] op_sel:[0,0] op_sel_hi:[1,0]
    v_pk_fma_f32 v[20:21], v[76:77], v[106:107], v[20:21] op_sel:[0,0,0] op_sel_hi:[1,0,1]
    v_pk_fma_f32 v[22:23], v[78:79], v[106:107], v[22:23] op_sel:[0,0,0] op_sel_hi:[1,0,1]
    v_pk_fma_f32 v[20:21], v[80:81], v[108:109], v[20:21] op_sel:[0,0,0] op_sel_hi:[1,0,1]
    v_pk_fma_f32 v[22:23], v[82:83], v[108:109], v[22:23] op_sel:[0,0,0] op_sel_hi:[1,0,1]
    v_and_or_b32 v20, v20, s101, v200
    v_and_or_b32 v21, v21, s101, v201
    v_and_or_b32 v22, v22, s101, v202
    v_and_or_b32 v23, v23, s101, v203
    s_cbranch_execz L_sk1
    buffer_store_dwordx4 v[20:23], v14, s[12:15], s48 offen sc1
L_sk1:
    v_mul_f32 v17, v105, v104
    v_fmac_f32 v17, v107, v106
    v_fmac_f32 v17, v109, v108
    v_or_b32 v24, v16, v200
    v_mov_b32 v26, v202
    v_mov_b32 v27, v203
    v_and_or_b32 v25, v17, s101, v201
    s_cbranch_execz L_sk2
    s_mov_b64 exec, 1
    buffer_store_dwordx4 v[24:27], v18, s[12:15], s49 offen sc1
    s_mov_b64 exec, -1
L_b1:
    s_cmp_lt_u32 s3, 4
    s_cbranch_scc1 L_end
    s_and_b32 s3, s3, 3
    s_cmp_eq_u32 s53, 0
    s_cbranch_scc1 L_end
    s_mov_b32 s52, 1048576
    v_mov_b32 v11, 0
L_lv:
    ds_read_b32 v12, v11 offset:524
    s_waitcnt lgkmcnt(0)
    v_readfirstlane_b32 s48, v12
    s_nop 0
    s_cmp_ge_u32 s48, 4
    s_cbranch_scc1 L_lv_ok
    s_sleep 2
    s_sub_u32 s52, s52, 1
    s_cbranch_scc0 L_lv
    s_endpgm
L_lv_ok:
    s_mov_b32 s52, 1048576
    v_mov_b32 v11, 0
L_lw:
    ds_read_b32 v12, v11 offset:560
    s_waitcnt lgkmcnt(0)
    v_readfirstlane_b32 s48, v12
    s_nop 0
    s_cmp_ge_u32 s48, 5
    s_cbranch_scc1 L_lw_ok
    s_sleep 2
    s_sub_u32 s52, s52, 1
    s_cbranch_scc0 L_lw
    s_endpgm
L_lw_ok:
    s_mov_b32 s52, 1048576
    v_mov_b32 v11, 0
L_lx:
    ds_read_b32 v12, v11 offset:564
    s_waitcnt lgkmcnt(0)
    v_readfirstlane_b32 s48, v12
    s_nop 0
    s_cmp_ge_u32 s48, 5
    s_cbranch_scc1 L_lx_ok
    s_sleep 2
    s_sub_u32 s52, s52, 1
    s_cbranch_scc0 L_lx
    s_endpgm
L_lx_ok:
    s_cmp_eq_u32 s53, 1
    s_cbranch_scc1 L_stw
    v_lshlrev_b32 v13, 4, v0
    v_mov_b32 v18, s42
    v_lshrrev_b32 v19, 16, v18
    s_mov_b32 s52, 131072
    s_mul_i32 s48, s3, 6144
    s_add_u32 s48, s48, 0x80000
    s_add_u32 s49, s48, 4096
L_tgl:
    buffer_load_dwordx4 v[72:75], v13, s[12:15], s48 offen offset:0 sc1
    buffer_load_dwordx4 v[76:79], v13, s[12:15], s48 offen offset:1024 sc1
    buffer_load_dwordx4 v[80:83], v13, s[12:15], s48 offen offset:2048 sc1
    buffer_load_dwordx4 v[84:87], v13, s[12:15], s48 offen offset:3072 sc1
    buffer_load_dwordx4 v[88:91], v13, s[12:15], s49 offen offset:0 sc1
    buffer_load_dwordx4 v[92:95], v13, s[12:15], s49 offen offset:1024 sc1
    s_waitcnt vmcnt(0)
    v_xor_b32 v14, v72, v18
    v_bitop3_b32 v14, v73, v19, v14 bitop3:0xbe
    v_bitop3_b32 v14, v74, v18, v14 bitop3:0xbe
    v_bitop3_b32 v14, v75, v19, v14 bitop3:0xbe
    v_bitop3_b32 v14, v76, v18, v14 bitop3:0xbe
    v_bitop3_b32 v14, v77, v19, v14 bitop3:0xbe
    v_bitop3_b32 v14, v78, v18, v14 bitop3:0xbe
    v_bitop3_b32 v14, v79, v19, v14 bitop3:0xbe
    v_bitop3_b32 v14, v80, v18, v14 bitop3:0xbe
    v_bitop3_b32 v14, v81, v19, v14 bitop3:0xbe
    v_bitop3_b32 v14, v82, v18, v14 bitop3:0xbe
    v_bitop3_b32 v14, v83, v19, v14 bitop3:0xbe
    v_bitop3_b32 v14, v84, v18, v14 bitop3:0xbe
    v_bitop3_b32 v14, v85, v19, v14 bitop3:0xbe
    v_bitop3_b32 v14, v86, v18, v14 bitop3:0xbe
    v_bitop3_b32 v14, v87, v19, v14 bitop3:0xbe
    v_bitop3_b32 v14, v88, v18, v14 bitop3:0xbe
    v_bitop3_b32 v14, v89, v19, v14 bitop3:0xbe
    v_bitop3_b32 v14, v90, v18, v14 bitop3:0xbe
    v_bitop3_b32 v14, v91, v19, v14 bitop3:0xbe
    v_bitop3_b32 v14, v92, v18, v14 bitop3:0xbe
    v_bitop3_b32 v14, v93, v19, v14 bitop3:0xbe
    v_bitop3_b32 v14, v94, v18, v14 bitop3:0xbe
    v_bitop3_b32 v14, v95, v19, v14 bitop3:0xbe
    v_and_b32 v14, 0xffff, v14
    v_cmp_ne_u32 vcc, 0, v14
    s_cbranch_vccz L_tgok
    s_sleep 8
    s_sub_u32 s52, s52, 1
    s_cbranch_scc0 L_tgl
    s_endpgm
L_tgok:
    v_and_b32 v72, 0xffff0000, v72
    v_and_b32 v73, 0xffff0000, v73
    v_and_b32 v74, 0xffff0000, v74
    v_and_b32 v75, 0xffff0000, v75
    v_and_b32 v76, 0xffff0000, v76
    v_and_b32 v77, 0xffff0000, v77
    v_and_b32 v78, 0xffff0000, v78
    v_and_b32 v79, 0xffff0000, v79
    v_and_b32 v80, 0xffff0000, v80
    v_and_b32 v81, 0xffff0000, v81
    v_and_b32 v82, 0xffff0000, v82
    v_and_b32 v83, 0xffff0000, v83
    v_and_b32 v84, 0xffff0000, v84
    v_and_b32 v85, 0xffff0000, v85
    v_and_b32 v86, 0xffff0000, v86
    v_and_b32 v87, 0xffff0000, v87
    v_and_b32 v88, 0xffff0000, v88
    v_and_b32 v89, 0xffff0000, v89
    v_and_b32 v90, 0xffff0000, v90
    v_and_b32 v91, 0xffff0000, v91
    v_and_b32 v92, 0xffff0000, v92
    v_and_b32 v93, 0xffff0000, v93
    v_and_b32 v94, 0xffff0000, v94
    v_and_b32 v95, 0xffff0000, v95
    s_and_b32 s48, s3, 1
    s_mul_i32 s48, s48, 6144
    s_add_u32 s48, s48, 6144
    v_add_u32 v13, s48, v13
    s_bfe_u32 s49, s3, 0x10001
    s_lshl_b32 s49, s49, 14
    s_mov_b32 s50, 0x3fff
    v_mov_b32 v15, s49
    v_add_u32 v14, 0, v13
    v_bfi_b32 v14, s50, v14, v15
    ds_write_b128 v14, v[72:75] offset:35840
    v_add_u32 v14, 1024, v13
    v_bfi_b32 v14, s50, v14, v15
    ds_write_b128 v14, v[76:79] offset:35840
    v_add_u32 v14, 2048, v13
    v_bfi_b32 v14, s50, v14, v15
    ds_write_b128 v14, v[80:83] offset:35840
    v_add_u32 v14, 3072, v13
    v_bfi_b32 v14, s50, v14, v15
    ds_write_b128 v14, v[84:87] offset:35840
    v_add_u32 v14, 4096, v13
    v_bfi_b32 v14, s50, v14, v15
    ds_write_b128 v14, v[88:91] offset:35840
    v_add_u32 v14, 5120, v13
    v_bfi_b32 v14, s50, v14, v15
    ds_write_b128 v14, v[92:95] offset:35840
    s_waitcnt lgkmcnt(0)
    s_branch L_nost
L_stw:
    s_mov_b32 s56, s24
    s_and_b32 s57, s25, 0xffff
    s_mov_b32 s58, 0x380000
    s_mov_b32 s59, 0x20000
    v_lshrrev_b32 v16, 3, v0
    v_mul_u32_u24 v16, 896, v16
    v_and_b32 v17, 7, v0
    v_lshl_add_u32 v16, v17, 4, v16
    s_lshl_b32 s48, s44, 2
    s_add_u32 s48, s48, s3
    s_mul_i32 s48, s48, 57344
    s_lshl_b32 s49, s54, 7
    s_add_u32 s48, s48, s49
    s_lshl_b32 s49, s3, 13
    s_add_u32 s49, s49, 35840
    s_add_u32 m0, s49, 0
    s_nop 0
    buffer_load_dwordx4 v16, s[56:59], s48 offen nt lds
    s_add_u32 m0, s49, 1024
    s_add_u32 s48, s48, 7168
    buffer_load_dwordx4 v16, s[56:59], s48 offen nt lds
    s_add_u32 m0, s49, 2048
    s_add_u32 s48, s48, 7168
    buffer_load_dwordx4 v16, s[56:59], s48 offen nt lds
    s_add_u32 m0, s49, 3072
    s_add_u32 s48, s48, 7168
    buffer_load_dwordx4 v16, s[56:59], s48 offen nt lds
    s_add_u32 m0, s49, 4096
    s_add_u32 s48, s48, 7168
    buffer_load_dwordx4 v16, s[56:59], s48 offen nt lds
    s_add_u32 m0, s49, 5120
    s_add_u32 s48, s48, 7168
    buffer_load_dwordx4 v16, s[56:59], s48 offen nt lds
    s_add_u32 m0, s49, 6144
    s_add_u32 s48, s48, 7168
    buffer_load_dwordx4 v16, s[56:59], s48 offen nt lds
    s_add_u32 m0, s49, 7168
    s_add_u32 s48, s48, 7168
    buffer_load_dwordx4 v16, s[56:59], s48 offen nt lds
    v_and_b32 v11, 15, v0
    v_lshrrev_b32 v12, 4, v0
L_nost:
    s_barrier
L_sk2:
    s_cmp_eq_u32 s53, 2
    s_cbranch_scc1 L_final
    s_cmp_lg_u32 s53, 1
    s_cbranch_scc1 L_tailend
    v_and_b32 v19, 3, v0
    v_lshlrev_b32 v14, 4, v19
    s_lshl_b32 s48, s3, 4
    s_add_u32 s48, s48, s44
    s_lshl_b32 s48, s48, 12
    s_add_u32 s48, s48, 0x20000
    s_lshl_b32 s49, s44, 8
    s_lshl_b32 s50, s3, 6
    s_add_u32 s49, s49, s50
    s_add_u32 s49, s49, 0x10000
    s_mov_b32 s52, 131072
    s_cbranch_execz L_sk3
    buffer_load_dwordx4 v[88:91], v14, s[12:15], s49 offen sc1
    buffer_load_dwordx4 v[72:75], v13, s[12:15], s48 offen offset:0 sc1
    buffer_load_dwordx4 v[76:79], v13, s[12:15], s48 offen offset:1024 sc1
    buffer_load_dwordx4 v[80:83], v13, s[12:15], s48 offen offset:2048 sc1
    buffer_load_dwordx4 v[84:87], v13, s[12:15], s48 offen offset:3072 sc1
L_sk3:
    v_lshrrev_b32 v15, 2, v11
    v_lshl_add_u32 v15, v12, 3, v15
    v_lshlrev_b32 v15, 7, v15
    v_lshl_add_u32 v15, v19, 3, v15
    s_lshl_b32 s50, s3, 5
    s_add_u32 s50, s50, 35840
    v_add_u32 v15, s50, v15
    s_cbranch_execz L_sk4
    s_waitcnt vmcnt(5)
    s_barrier
    ds_read_b64_tr_b16 v[104:105], v15 offset:0
    ds_read_b64_tr_b16 v[106:107], v15 offset:512
    ds_read_b64_tr_b16 v[108:109], v15 offset:4096
    ds_read_b64_tr_b16 v[110:111], v15 offset:4608
    ds_read_b64_tr_b16 v[112:113], v15 offset:8192
    ds_read_b64_tr_b16 v[114:115], v15 offset:8704
    ds_read_b64_tr_b16 v[116:117], v15 offset:12288
    ds_read_b64_tr_b16 v[118:119], v15 offset:12800
    ds_read_b64_tr_b16 v[120:121], v15 offset:16384
    ds_read_b64_tr_b16 v[122:123], v15 offset:16896
    ds_read_b64_tr_b16 v[124:125], v15 offset:20480
    ds_read_b64_tr_b16 v[126:127], v15 offset:20992
    ds_read_b64_tr_b16 v[128:129], v15 offset:24576
    ds_read_b64_tr_b16 v[130:131], v15 offset:25088
    ds_read_b64_tr_b16 v[132:133], v15 offset:28672
    ds_read_b64_tr_b16 v[134:135], v15 offset:29184
L_sk4:
    v_lshlrev_b32 v18, 3, v0
    s_lshl_b32 s50, s3, 9
    v_add_u32 v18, s50, v18
    v_lshlrev_b32 v19, 9, v19
    v_lshl_add_u32 v19, v12, 4, v19
    v_mul_u32_u24 v15, 28672, v11
    v_lshl_add_u32 v15, v12, 4, v15
    s_mul_i32 s55, s44, 1792
    s_lshl_b32 s50, s54, 8
    s_add_u32 s55, s55, s50
    s_lshl_b32 s50, s3, 6
    s_add_u32 s55, s55, s50
    s_add_u32 s55, s55, 0x60000
    s_branch L_ochk
L_opoll:
    s_cbranch_execz L_sk5
    buffer_load_dwordx4 v[88:91], v14, s[12:15], s49 offen sc1
    buffer_load_dwordx4 v[72:75], v13, s[12:15], s48 offen offset:0 sc1
    buffer_load_dwordx4 v[76:79], v13, s[12:15], s48 offen offset:1024 sc1
    buffer_load_dwordx4 v[80:83], v13, s[12:15], s48 offen offset:2048 sc1
    buffer_load_dwordx4 v[84:87], v13, s[12:15], s48 offen offset:3072 sc1
L_sk5:
L_ochk:
    s_waitcnt vmcnt(4)
    v_xor_b32 v88, v88, v200
    v_xor_b32 v89, v89, v201
    v_xor_b32 v90, v90, v202
    v_xor_b32 v91, v91, v203
    v_or3_b32 v17, v88, v89, v90
    v_max_f32_dpp v16, v88, v88 quad_perm:[1,0,3,2] row_mask:0xf bank_mask:0xf
    v_or_b32 v17, v17, v91
    s_nop 0
    v_max_f32_dpp v16, v16, v16 quad_perm:[2,3,0,1] row_mask:0xf bank_mask:0xf
    v_sub_f32 v16, v88, v16
    v_exp_f32 v16, v16
    s_nop 0
    v_mul_f32 v90, v16, v89
    s_nop 1
    v_add_f32_dpp v90, v90, v90 quad_perm:[1,0,3,2] row_mask:0xf bank_mask:0xf
    s_nop 1
    v_add_f32_dpp v90, v90, v90 quad_perm:[2,3,0,1] row_mask:0xf bank_mask:0xf
    v_rcp_f32 v90, v90
    s_waitcnt vmcnt(3)
    v_xor_b32 v168, v72, v200
    v_xor_b32 v169, v73, v201
    v_xor_b32 v170, v74, v202
    v_xor_b32 v171, v75, v203
    v_or3_b32 v17, v17, v168, v169
    v_mul_f32_dpp v20, v16, v168 quad_perm:[0,0,0,0] row_mask:0xf bank_mask:0xf
    v_mul_f32_dpp v21, v16, v169 quad_perm:[0,0,0,0] row_mask:0xf bank_mask:0xf
    v_mul_f32_dpp v22, v16, v170 quad_perm:[0,0,0,0] row_mask:0xf bank_mask:0xf
    v_mul_f32_dpp v23, v16, v171 quad_perm:[0,0,0,0] row_mask:0xf bank_mask:0xf
    v_or3_b32 v17, v17, v170, v171
    s_waitcnt vmcnt(2)
    v_xor_b32 v172, v76, v200
    v_xor_b32 v173, v77, v201
    v_xor_b32 v174, v78, v202
    v_xor_b32 v175, v79, v203
    v_or3_b32 v17, v17, v172, v173
    v_fmac_f32_dpp v20, v16, v172 quad_perm:[1,1,1,1] row_mask:0xf bank_mask:0xf
    v_fmac_f32_dpp v21, v16, v173 quad_perm:[1,1,1,1] row_mask:0xf bank_mask:0xf
    v_fmac_f32_dpp v22, v16, v174 quad_perm:[1,1,1,1] row_mask:0xf bank_mask:0xf
    v_fmac_f32_dpp v23, v16, v175 quad_perm:[1,1,1,1] row_mask:0xf bank_mask:0xf
    v_or3_b32 v17, v17, v174, v175
    s_waitcnt vmcnt(1)
    v_xor_b32 v176, v80, v200
    v_xor_b32 v177, v81, v201
    v_xor_b32 v178, v82, v202
    v_xor_b32 v179, v83, v203
    v_or3_b32 v17, v17, v176, v177
    v_fmac_f32_dpp v20, v16, v176 quad_perm:[2,2,2,2] row_mask:0xf bank_mask:0xf
    v_fmac_f32_dpp v21, v16, v177 quad_perm:[2,2,2,2] row_mask:0xf bank_mask:0xf
    v_fmac_f32_dpp v22, v16, v178 quad_perm:[2,2,2,2] row_mask:0xf bank_mask:0xf
    v_fmac_f32_dpp v23, v16, v179 quad_perm:[2,2,2,2] row_mask:0xf bank_mask:0xf
    v_or3_b32 v17, v17, v178, v179
    s_waitcnt vmcnt(0)
    v_xor_b32 v180, v84, v200
    v_xor_b32 v181, v85, v201
    v_xor_b32 v182, v86, v202
    v_xor_b32 v183, v87, v203
    v_or3_b32 v17, v17, v180, v181
    v_fmac_f32_dpp v20, v16, v180 quad_perm:[3,3,3,3] row_mask:0xf bank_mask:0xf
    v_fmac_f32_dpp v21, v16, v181 quad_perm:[3,3,3,3] row_mask:0xf bank_mask:0xf
    v_fmac_f32_dpp v22, v16, v182 quad_perm:[3,3,3,3] row_mask:0xf bank_mask:0xf
    v_fmac_f32_dpp v23, v16, v183 quad_perm:[3,3,3,3] row_mask:0xf bank_mask:0xf
    v_or3_b32 v17, v17, v182, v183
    v_and_b32 v17, 0xff, v17
    v_cmp_ne_u32 vcc, 0, v17
    v_pk_mul_f32 v[20:21], v[20:21], v[90:91] op_sel:[0,0] op_sel_hi:[1,0]
    v_pk_mul_f32 v[22:23], v[22:23], v[90:91] op_sel:[0,0] op_sel_hi:[1,0]
    s_cbranch_vccz L_ook
    s_sub_u32 s52, s52, 1
    s_cbranch_scc0 L_opoll
    s_endpgm
L_ook:
    v_cvt_pk_bf16_f32 v16, v20, v21
    v_cvt_pk_bf16_f32 v17, v22, v23
    ds_write_b64 v18, v[16:17] offset:8832
    s_waitcnt lgkmcnt(0)
    s_cbranch_execz L_sk6
    s_barrier
L_sk6:
    ds_read_b128 v[136:139], v19 offset:8832
    ds_read_b128 v[140:143], v19 offset:8896
    ds_read_b128 v[144:147], v19 offset:8960
    ds_read_b128 v[148:151], v19 offset:9024
    ds_read_b128 v[152:155], v19 offset:9088
    ds_read_b128 v[156:159], v19 offset:9152
    ds_read_b128 v[160:163], v19 offset:9216
    ds_read_b128 v[164:167], v19 offset:9280
    s_waitcnt lgkmcnt(7)
    v_mfma_f32_16x16x32_bf16 v[20:23], v[104:107], v[136:139], 0
    s_waitcnt lgkmcnt(6)
    v_mfma_f32_16x16x32_bf16 v[24:27], v[108:111], v[140:143], 0
    s_waitcnt lgkmcnt(5)
    v_mfma_f32_16x16x32_bf16 v[20:23], v[112:115], v[144:147], v[20:23]
    s_waitcnt lgkmcnt(4)
    v_mfma_f32_16x16x32_bf16 v[24:27], v[116:119], v[148:151], v[24:27]
    s_waitcnt lgkmcnt(3)
    v_mfma_f32_16x16x32_bf16 v[20:23], v[120:123], v[152:155], v[20:23]
    s_waitcnt lgkmcnt(2)
    v_mfma_f32_16x16x32_bf16 v[24:27], v[124:127], v[156:159], v[24:27]
    s_waitcnt lgkmcnt(1)
    v_mfma_f32_16x16x32_bf16 v[20:23], v[128:131], v[160:163], v[20:23]
    s_waitcnt lgkmcnt(0)
    v_mfma_f32_16x16x32_bf16 v[24:27], v[132:135], v[164:167], v[24:27]
    s_and_b32 exec_lo, s83, 0xf000f
    s_and_b32 exec_hi, s83, 0xf000f
    s_nop 5
    v_pk_add_f32 v[20:21], v[20:21], v[24:25]
    v_pk_add_f32 v[22:23], v[22:23], v[26:27]
    v_and_or_b32 v20, v20, s101, v200
    v_and_or_b32 v21, v21, s101, v201
    v_and_or_b32 v22, v22, s101, v202
    v_and_or_b32 v23, v23, s101, v203
    s_cbranch_execz L_sk7
    buffer_store_dwordx4 v[20:23], v15, s[12:15], s55 offen sc1
L_sk7:
    s_branch L_tailend
L_final:
    s_cbranch_execz L_sk8
    s_and_b32 s44, s44, 3
L_sk8:
    v_mov_b32 v28, 0
    v_mov_b32 v68, 0
    v_mov_b32 v29, 0
    v_mov_b32 v69, 0
    v_mov_b32 v30, 0
    v_mov_b32 v70, 0
    v_mov_b32 v31, 0
    v_mov_b32 v71, 0
    v_mov_b32 v76, v200
    v_mov_b32 v77, v201
    v_mov_b32 v78, v202
    v_mov_b32 v79, v203
    v_mov_b32 v84, v200
    v_mov_b32 v85, v201
    v_mov_b32 v86, v202
    v_mov_b32 v87, v203
    v_mov_b32 v92, v200
    v_mov_b32 v93, v201
    v_mov_b32 v94, v202
    v_mov_b32 v95, v203
    v_mov_b32 v100, v200
    v_mov_b32 v101, v201
    v_mov_b32 v102, v202
    v_mov_b32 v103, v203
    v_lshlrev_b32 v13, 4, v0
    v_lshlrev_b32 v15, 3, v0
    s_mul_i32 s48, s44, 896
    v_add_u32 v15, s48, v15
    s_xor_b32 s48, s3, 0
    s_lshl_b32 s48, s48, 11
    v_add_u32 v32, s48, v13
    s_xor_b32 s48, s3, 1
    s_lshl_b32 s48, s48, 11
    v_add_u32 v33, s48, v13
    s_xor_b32 s48, s3, 2
    s_lshl_b32 s48, s48, 11
    v_add_u32 v34, s48, v13
    s_xor_b32 s48, s3, 3
    s_lshl_b32 s48, s48, 11
    v_add_u32 v35, s48, v13
    s_lshl_b32 s48, s44, 4
    s_lshl_b32 s49, s3, 2
    s_add_u32 s48, s48, s49
    s_mul_i32 s48, s48, 1792
    s_add_u32 s48, s48, 0x60000
    s_add_u32 s49, s48, 3584
    s_mov_b32 s52, 131072
    s_bitcmp1_b32 s3, 0
    s_cselect_b64 s[84:85], -1, 0
    s_bitcmp1_b32 s3, 1
    s_cselect_b64 s[86:87], -1, 0
    s_cselect_b32 s91, 0xffff, -1
    s_movk_i32 s88, 0x3fff
    s_mov_b32 s89, 0x6c000000
    s_mov_b32 s90, 0x18000000
    s_cbranch_execz L_sk9
    global_load_dwordx2 v[68:69], v15, s[16:17]
    s_mov_b32 exec_hi, 0xffff
    global_load_dwordx2 v[70:71], v15, s[16:17] offset:512
    s_mov_b32 exec_hi, -1
    s_waitcnt vmcnt(0)
L_sk9:
    v_lshlrev_b32 v48, 16, v68
    v_and_b32 v49, 0xffff0000, v68
    v_lshlrev_b32 v50, 16, v69
    v_and_b32 v51, 0xffff0000, v69
    v_lshlrev_b32 v52, 16, v70
    v_and_b32 v53, 0xffff0000, v70
    v_lshlrev_b32 v54, 16, v71
    v_and_b32 v55, 0xffff0000, v71
    s_and_b32 s50, s3, 1
    s_lshl_b32 s50, s50, 2
    s_and_b32 s55, s3, 2
    s_lshl_b32 s55, s55, 8
    s_add_u32 s50, s50, s55
    v_add_u32 v15, s50, v15
L_zpoll:
    s_cbranch_execz L_sk10
    buffer_load_dwordx4 v[72:75], v13, s[12:15], s48 offen offset:0 sc1
    buffer_load_dwordx4 v[80:83], v13, s[12:15], s48 offen offset:1792 sc1
    buffer_load_dwordx4 v[88:91], v13, s[12:15], s49 offen offset:0 sc1
    buffer_load_dwordx4 v[96:99], v13, s[12:15], s49 offen offset:1792 sc1
    s_mov_b32 exec_hi, 0xffff
    buffer_load_dwordx4 v[76:79], v13, s[12:15], s48 offen offset:1024 sc1
    buffer_load_dwordx4 v[84:87], v13, s[12:15], s48 offen offset:2816 sc1
    buffer_load_dwordx4 v[92:95], v13, s[12:15], s49 offen offset:1024 sc1
    buffer_load_dwordx4 v[100:103], v13, s[12:15], s49 offen offset:2816 sc1
    s_mov_b32 exec_hi, -1
    s_waitcnt vmcnt(0)
L_sk10:
    v_xor_b32 v104, v72, v200
    v_xor_b32 v105, v73, v201
    v_xor_b32 v106, v74, v202
    v_xor_b32 v107, v75, v203
    v_xor_b32 v108, v76, v200
    v_xor_b32 v109, v77, v201
    v_xor_b32 v110, v78, v202
    v_xor_b32 v111, v79, v203
    v_xor_b32 v112, v80, v200
    v_xor_b32 v113, v81, v201
    v_xor_b32 v114, v82, v202
    v_xor_b32 v115, v83, v203
    v_xor_b32 v116, v84, v200
    v_xor_b32 v117, v85, v201
    v_xor_b32 v118, v86, v202
    v_xor_b32 v119, v87, v203
    v_xor_b32 v120, v88, v200
    v_xor_b32 v121, v89, v201
    v_xor_b32 v122, v90, v202
    v_xor_b32 v123, v91, v203
    v_xor_b32 v124, v92, v200
    v_xor_b32 v125, v93, v201
    v_xor_b32 v126, v94, v202
    v_xor_b32 v127, v95, v203
    v_xor_b32 v128, v96, v200
    v_xor_b32 v129, v97, v201
    v_xor_b32 v130, v98, v202
    v_xor_b32 v131, v99, v203
    v_xor_b32 v132, v100, v200
    v_xor_b32 v133, v101, v201
    v_xor_b32 v134, v102, v202
    v_xor_b32 v135, v103, v203
    v_or3_b32 v16, v104, v105, v106
    v_or3_b32 v17, v107, v108, v109
    v_or3_b32 v16, v16, v110, v111
    v_or3_b32 v17, v17, v112, v113
    v_or3_b32 v16, v16, v114, v115
    v_or3_b32 v17, v17, v116, v117
    v_or3_b32 v16, v16, v118, v119
    v_or3_b32 v17, v17, v120, v121
    v_or3_b32 v16, v16, v122, v123
    v_or3_b32 v17, v17, v124, v125
    v_or3_b32 v16, v16, v126, v127
    v_or3_b32 v17, v17, v128, v129
    v_or3_b32 v16, v16, v130, v131
    v_or3_b32 v17, v17, v132, v133
    v_or3_b32 v16, v16, v134, v135
    v_bitop3_b32 v16, v16, v17, s101 bitop3:0x54
    v_cmp_ne_u32 vcc, 0, v16
    s_cbranch_vccz L_zok
    s_sub_u32 s52, s52, 1
    s_cbranch_scc0 L_zpoll
    s_endpgm
L_zok:
    v_pk_add_f32 v[104:105], v[104:105], v[112:113]
    v_pk_add_f32 v[120:121], v[120:121], v[128:129]
    v_pk_add_f32 v[106:107], v[106:107], v[114:115]
    v_pk_add_f32 v[122:123], v[122:123], v[130:131]
    v_pk_add_f32 v[108:109], v[108:109], v[116:117]
    v_pk_add_f32 v[124:125], v[124:125], v[132:133]
    v_pk_add_f32 v[110:111], v[110:111], v[118:119]
    v_pk_add_f32 v[126:127], v[126:127], v[134:135]
    v_pk_add_f32 v[104:105], v[104:105], v[120:121]
    v_pk_add_f32 v[106:107], v[106:107], v[122:123]
    v_pk_add_f32 v[108:109], v[108:109], v[124:125]
    v_pk_add_f32 v[110:111], v[110:111], v[126:127]
    ds_write_b128 v32, v[104:107] offset:14464
    ds_write_b128 v32, v[108:111] offset:15488
    s_waitcnt lgkmcnt(0)
    s_cbranch_execz L_sk11
    s_barrier
L_sk11:
    ds_read_b128 v[112:115], v33 offset:14464
    ds_read_b128 v[116:119], v33 offset:15488
    ds_read_b128 v[120:123], v34 offset:14464
    ds_read_b128 v[124:127], v34 offset:15488
    ds_read_b128 v[128:131], v35 offset:14464
    ds_read_b128 v[132:135], v35 offset:15488
    s_waitcnt lgkmcnt(0)
    v_pk_add_f32 v[104:105], v[104:105], v[112:113]
    v_pk_add_f32 v[120:121], v[120:121], v[128:129]
    v_pk_add_f32 v[106:107], v[106:107], v[114:115]
    v_pk_add_f32 v[122:123], v[122:123], v[130:131]
    v_pk_add_f32 v[108:109], v[108:109], v[116:117]
    v_pk_add_f32 v[124:125], v[124:125], v[132:133]
    v_pk_add_f32 v[110:111], v[110:111], v[118:119]
    v_pk_add_f32 v[126:127], v[126:127], v[134:135]
    v_pk_add_f32 v[104:105], v[104:105], v[120:121]
    v_pk_add_f32 v[106:107], v[106:107], v[122:123]
    v_pk_add_f32 v[108:109], v[108:109], v[124:125]
    v_pk_add_f32 v[110:111], v[110:111], v[126:127]
    v_cvt_pk_bf16_f32 v64, v104, v105
    v_cvt_pk_bf16_f32 v65, v106, v107
    v_cvt_pk_bf16_f32 v66, v108, v109
    v_cvt_pk_bf16_f32 v67, v110, v111
    v_lshlrev_b32 v56, 16, v64
    v_and_b32 v57, 0xffff0000, v64
    v_lshlrev_b32 v58, 16, v65
    v_and_b32 v59, 0xffff0000, v65
    v_lshlrev_b32 v60, 16, v66
    v_and_b32 v61, 0xffff0000, v66
    v_lshlrev_b32 v62, 16, v67
    v_and_b32 v63, 0xffff0000, v67
    v_pk_add_f32 v[56:57], v[56:57], v[48:49]
    v_pk_add_f32 v[58:59], v[58:59], v[50:51]
    v_pk_add_f32 v[60:61], v[60:61], v[52:53]
    v_pk_add_f32 v[62:63], v[62:63], v[54:55]
    v_cvt_pk_bf16_f32 v44, v56, v57
    v_cvt_pk_bf16_f32 v45, v58, v59
    v_cvt_pk_bf16_f32 v46, v60, v61
    v_cvt_pk_bf16_f32 v47, v62, v63
    v_lshlrev_b32 v56, 16, v44
    v_and_b32 v57, 0xffff0000, v44
    v_lshlrev_b32 v58, 16, v45
    v_and_b32 v59, 0xffff0000, v45
    v_lshlrev_b32 v60, 16, v46
    v_and_b32 v61, 0xffff0000, v46
    v_lshlrev_b32 v62, 16, v47
    v_and_b32 v63, 0xffff0000, v47
    v_readfirstlane_b32 s60, v56
    s_nop 1
    v_pk_add_f32 v[24:25], v[56:57], s[60:61] op_sel_hi:[1,0] neg_lo:[0,1] neg_hi:[0,1]
    v_pk_add_f32 v[26:27], v[58:59], s[60:61] op_sel_hi:[1,0] neg_lo:[0,1] neg_hi:[0,1]
    s_and_b32 exec_hi, s83, 0xffff
    v_pk_add_f32 v[28:29], v[60:61], s[60:61] op_sel_hi:[1,0] neg_lo:[0,1] neg_hi:[0,1]
    v_pk_add_f32 v[30:31], v[62:63], s[60:61] op_sel_hi:[1,0] neg_lo:[0,1] neg_hi:[0,1]
    s_mov_b32 exec_hi, s83
    v_pk_mul_f32 v[22:23], v[24:25], v[24:25]
    v_pk_add_f32 v[64:65], v[24:25], v[26:27]
    v_pk_fma_f32 v[22:23], v[26:27], v[26:27], v[22:23]
    v_pk_add_f32 v[66:67], v[28:29], v[30:31]
    v_pk_fma_f32 v[22:23], v[28:29], v[28:29], v[22:23]
    v_pk_add_f32 v[64:65], v[64:65], v[66:67]
    v_pk_fma_f32 v[22:23], v[30:31], v[30:31], v[22:23]
    v_add_f32 v20, v64, v65
    v_add_f32 v21, v22, v23
    s_nop 0
    v_add_f32_dpp v20, v20, v20 row_ror:8 row_mask:0xf bank_mask:0xf
    v_add_f32_dpp v21, v21, v21 row_ror:8 row_mask:0xf bank_mask:0xf
    s_nop 0
    v_add_f32_dpp v20, v20, v20 row_ror:4 row_mask:0xf bank_mask:0xf
    v_add_f32_dpp v21, v21, v21 row_ror:4 row_mask:0xf bank_mask:0xf
    s_nop 0
    v_add_f32_dpp v20, v20, v20 row_ror:2 row_mask:0xf bank_mask:0xf
    v_add_f32_dpp v21, v21, v21 row_ror:2 row_mask:0xf bank_mask:0xf
    s_nop 0
    v_add_f32_dpp v20, v20, v20 row_ror:1 row_mask:0xf bank_mask:0xf
    v_add_f32_dpp v21, v21, v21 row_ror:1 row_mask:0xf bank_mask:0xf
    v_mov_b32 v22, v20
    v_mov_b32 v23, v21
    s_nop 0
    v_permlane16_swap_b32 v20, v22
    v_permlane16_swap_b32 v21, v23
    v_pk_add_f32 v[20:21], v[20:21], v[22:23]
    v_mov_b32 v22, v20
    v_mov_b32 v23, v21
    s_nop 0
    v_permlane32_swap_b32 v20, v22
    v_permlane32_swap_b32 v21, v23
    v_pk_add_f32 v[20:21], v[20:21], v[22:23]
    v_mul_f32 v22, 0x3b124925, v20
    v_mul_f32 v23, 0x3b124925, v21
    v_fma_f32 v23, -v22, v22, v23
    v_add_f32 v22, s60, v22
    v_max_f32 v23, 0, v23
    v_cvt_pk_bf16_f32 v22, v23, v22
    v_lshlrev_b32 v23, 16, v22
    v_and_b32 v22, 0xffff0000, v22
    v_add_f32 v23, 0x3727c5ac, v23
    v_pk_add_f32 v[56:57], v[56:57], v[22:23] op_sel_hi:[1,0] neg_lo:[0,1] neg_hi:[0,1]
    v_pk_add_f32 v[58:59], v[58:59], v[22:23] op_sel_hi:[1,0] neg_lo:[0,1] neg_hi:[0,1]
    v_pk_add_f32 v[60:61], v[60:61], v[22:23] op_sel_hi:[1,0] neg_lo:[0,1] neg_hi:[0,1]
    v_pk_add_f32 v[62:63], v[62:63], v[22:23] op_sel_hi:[1,0] neg_lo:[0,1] neg_hi:[0,1]
    v_cvt_pk_bf16_f32 v23, v23, v23
    v_and_b32 v23, 0xffff0000, v23
    v_sqrt_f32 v23, v23
    v_cvt_pk_bf16_f32 v64, v56, v57
    v_cvt_pk_bf16_f32 v65, v58, v59
    v_cvt_pk_bf16_f32 v66, v60, v61
    v_cvt_pk_bf16_f32 v67, v62, v63
    v_cvt_pk_bf16_f32 v23, v23, v23
    v_and_b32 v23, 0xffff0000, v23
    v_rcp_f32 v23, v23
    v_lshlrev_b32 v56, 16, v64
    v_and_b32 v57, 0xffff0000, v64
    v_lshlrev_b32 v58, 16, v65
    v_and_b32 v59, 0xffff0000, v65
    v_lshlrev_b32 v60, 16, v66
    v_and_b32 v61, 0xffff0000, v66
    v_lshlrev_b32 v62, 16, v67
    v_and_b32 v63, 0xffff0000, v67
    v_pk_mul_f32 v[56:57], v[56:57], v[22:23] op_sel:[0,1] op_sel_hi:[1,1]
    v_pk_mul_f32 v[58:59], v[58:59], v[22:23] op_sel:[0,1] op_sel_hi:[1,1]
    v_pk_mul_f32 v[60:61], v[60:61], v[22:23] op_sel:[0,1] op_sel_hi:[1,1]
    v_pk_mul_f32 v[62:63], v[62:63], v[22:23] op_sel:[0,1] op_sel_hi:[1,1]
    v_cvt_pk_bf16_f32 v64, v56, v57
    v_cvt_pk_bf16_f32 v65, v58, v59
    v_cvt_pk_bf16_f32 v66, v60, v61
    v_cvt_pk_bf16_f32 v67, v62, v63
    v_lshlrev_b32 v56, 16, v64
    v_and_b32 v57, 0xffff0000, v64
    v_lshlrev_b32 v58, 16, v65
    v_and_b32 v59, 0xffff0000, v65
    v_lshlrev_b32 v60, 16, v66
    v_and_b32 v61, 0xffff0000, v66
    v_lshlrev_b32 v62, 16, v67
    v_and_b32 v63, 0xffff0000, v67
    v_readfirstlane_b32 s60, v56
    s_nop 1
    v_pk_add_f32 v[24:25], v[56:57], s[60:61] op_sel_hi:[1,0] neg_lo:[0,1] neg_hi:[0,1]
    v_pk_add_f32 v[26:27], v[58:59], s[60:61] op_sel_hi:[1,0] neg_lo:[0,1] neg_hi:[0,1]
    s_and_b32 exec_hi, s83, 0xffff
    v_pk_add_f32 v[28:29], v[60:61], s[60:61] op_sel_hi:[1,0] neg_lo:[0,1] neg_hi:[0,1]
    v_pk_add_f32 v[30:31], v[62:63], s[60:61] op_sel_hi:[1,0] neg_lo:[0,1] neg_hi:[0,1]
    s_mov_b32 exec_hi, s83
    v_pk_mul_f32 v[22:23], v[24:25], v[24:25]
    v_pk_add_f32 v[64:65], v[24:25], v[26:27]
    v_pk_fma_f32 v[22:23], v[26:27], v[26:27], v[22:23]
    v_pk_add_f32 v[66:67], v[28:29], v[30:31]
    v_pk_fma_f32 v[22:23], v[28:29], v[28:29], v[22:23]
    v_pk_add_f32 v[64:65], v[64:65], v[66:67]
    v_pk_fma_f32 v[22:23], v[30:31], v[30:31], v[22:23]
    v_add_f32 v20, v64, v65
    v_add_f32 v21, v22, v23
    s_nop 0
    v_add_f32_dpp v20, v20, v20 row_ror:8 row_mask:0xf bank_mask:0xf
    v_add_f32_dpp v21, v21, v21 row_ror:8 row_mask:0xf bank_mask:0xf
    s_nop 0
    v_add_f32_dpp v20, v20, v20 row_ror:4 row_mask:0xf bank_mask:0xf
    v_add_f32_dpp v21, v21, v21 row_ror:4 row_mask:0xf bank_mask:0xf
    s_nop 0
    v_add_f32_dpp v20, v20, v20 row_ror:2 row_mask:0xf bank_mask:0xf
    v_add_f32_dpp v21, v21, v21 row_ror:2 row_mask:0xf bank_mask:0xf
    s_nop 0
    v_add_f32_dpp v20, v20, v20 row_ror:1 row_mask:0xf bank_mask:0xf
    v_add_f32_dpp v21, v21, v21 row_ror:1 row_mask:0xf bank_mask:0xf
    v_mov_b32 v22, v20
    v_mov_b32 v23, v21
    s_nop 0
    v_permlane16_swap_b32 v20, v22
    v_permlane16_swap_b32 v21, v23
    v_pk_add_f32 v[20:21], v[20:21], v[22:23]
    v_mov_b32 v22, v20
    v_mov_b32 v23, v21
    s_nop 0
    v_permlane32_swap_b32 v20, v22
    v_permlane32_swap_b32 v21, v23
    v_pk_add_f32 v[20:21], v[20:21], v[22:23]
    v_mul_f32 v22, 0x3b124925, v20
    v_mul_f32 v23, 0x3b124925, v21
    v_fma_f32 v23, -v22, v22, v23
    v_add_f32 v22, s60, v22
    v_max_f32 v23, 0, v23
    v_cvt_pk_bf16_f32 v22, v23, v22
    v_lshlrev_b32 v23, 16, v22
    v_and_b32 v22, 0xffff0000, v22
    v_add_f32 v23, 0x3727c5ac, v23
    v_pk_add_f32 v[56:57], v[56:57], v[22:23] op_sel_hi:[1,0] neg_lo:[0,1] neg_hi:[0,1]
    v_pk_add_f32 v[58:59], v[58:59], v[22:23] op_sel_hi:[1,0] neg_lo:[0,1] neg_hi:[0,1]
    v_pk_add_f32 v[60:61], v[60:61], v[22:23] op_sel_hi:[1,0] neg_lo:[0,1] neg_hi:[0,1]
    v_pk_add_f32 v[62:63], v[62:63], v[22:23] op_sel_hi:[1,0] neg_lo:[0,1] neg_hi:[0,1]
    v_cvt_pk_bf16_f32 v23, v23, v23
    v_and_b32 v23, 0xffff0000, v23
    v_sqrt_f32 v23, v23
    v_cvt_pk_bf16_f32 v64, v56, v57
    v_cvt_pk_bf16_f32 v65, v58, v59
    v_cvt_pk_bf16_f32 v66, v60, v61
    v_cvt_pk_bf16_f32 v67, v62, v63
    v_cvt_pk_bf16_f32 v23, v23, v23
    v_and_b32 v23, 0xffff0000, v23
    v_rcp_f32 v23, v23
    v_lshlrev_b32 v56, 16, v64
    v_and_b32 v57, 0xffff0000, v64
    v_lshlrev_b32 v58, 16, v65
    v_and_b32 v59, 0xffff0000, v65
    v_lshlrev_b32 v60, 16, v66
    v_and_b32 v61, 0xffff0000, v66
    v_lshlrev_b32 v62, 16, v67
    v_and_b32 v63, 0xffff0000, v67
    v_pk_mul_f32 v[56:57], v[56:57], v[22:23] op_sel:[0,1] op_sel_hi:[1,1]
    v_pk_mul_f32 v[58:59], v[58:59], v[22:23] op_sel:[0,1] op_sel_hi:[1,1]
    v_pk_mul_f32 v[60:61], v[60:61], v[22:23] op_sel:[0,1] op_sel_hi:[1,1]
    v_pk_mul_f32 v[62:63], v[62:63], v[22:23] op_sel:[0,1] op_sel_hi:[1,1]
    v_cvt_pk_bf16_f32 v64, v56, v57
    v_cvt_pk_bf16_f32 v65, v58, v59
    v_cvt_pk_bf16_f32 v66, v60, v61
    v_cvt_pk_bf16_f32 v67, v62, v63
    s_and_b32 exec_hi, s83, s91
    v_cndmask_b32 v64, v64, v65, s[84:85]
    v_cndmask_b32 v66, v66, v67, s[84:85]
    v_cndmask_b32 v44, v44, v45, s[84:85]
    v_cndmask_b32 v46, v46, v47, s[84:85]
    v_cndmask_b32 v64, v64, v66, s[86:87]
    v_cndmask_b32 v44, v44, v46, s[86:87]
    v_lshlrev_b32 v56, 16, v64
    v_and_b32 v57, 0xffff0000, v64
    v_lshrrev_b32 v16, 14, v56
    v_lshrrev_b32 v18, 17, v56
    v_bfi_b32 v16, s88, v16, v18
    ds_read_b32 v40, v16 offset:35840
    v_lshrrev_b32 v17, 14, v57
    v_lshrrev_b32 v19, 17, v57
    v_bfi_b32 v17, s88, v17, v19
    ds_read_b32 v41, v17 offset:35840
    v_lshlrev_b32 v48, 16, v44
    v_and_b32 v49, 0xffff0000, v44
    v_lshlrev_b32 v16, 1, v56
    v_subrev_u32 v16, s89, v16
    v_lshlrev_b32 v17, 1, v57
    v_subrev_u32 v17, s89, v17
    v_max_u32 v16, v16, v17
    v_cmp_le_u32 vcc, s90, v16
    s_waitcnt lgkmcnt(0)
    s_cbranch_vccnz L_fallback
L_nofb:
    v_pk_add_f32 v[48:49], v[48:49], v[40:41]
    v_cvt_pk_bf16_f32 v64, v48, v49
    s_cbranch_execz L_sk12
    global_store_dword v15, v64, s[36:37]
    s_or_b32 s48, s44, s3
    s_cmp_lg_u32 s48, 0
    s_cbranch_scc1 L_fin2
    s_mov_b64 exec, 1
    v_mov_b32 v13, 0
    v_mov_b32 v14, s42
    buffer_store_dword v14, v13, s[12:15], 0 offen sc1
L_fin2:
L_sk12:
L_tailend:
    s_cbranch_execnz L_end
    s_mov_b32 s83, -1
    s_mov_b64 exec, -1
    s_branch L_b1
L_end:
L_abort:
    s_endpgm
L_fallback:
    s_mov_b64 exec, -1
    v_lshlrev_b32 v13, 3, v0
    ds_read_b64 v[142:143], v13 offset:22912
    ds_read_b64 v[156:157], v13 offset:27008
    ds_read_b64 v[128:129], v13 offset:31104
    ds_read_b64 v[144:145], v13 offset:23424
    ds_read_b64 v[158:159], v13 offset:27520
    ds_read_b64 v[130:131], v13 offset:31616
    ds_read_b64 v[146:147], v13 offset:23936
    ds_read_b64 v[160:161], v13 offset:28032
    ds_read_b64 v[132:133], v13 offset:32128
    ds_read_b64 v[148:149], v13 offset:24448
    ds_read_b64 v[162:163], v13 offset:28544
    ds_read_b64 v[134:135], v13 offset:32640
    ds_read_b64 v[150:151], v13 offset:24960
    ds_read_b64 v[164:165], v13 offset:29056
    ds_read_b64 v[136:137], v13 offset:33152
    ds_read_b64 v[152:153], v13 offset:25472
    ds_read_b64 v[166:167], v13 offset:29568
    ds_read_b64 v[138:139], v13 offset:33664
    ds_read_b64 v[154:155], v13 offset:25984
    ds_read_b64 v[168:169], v13 offset:30080
    ds_read_b64 v[140:141], v13 offset:34176
    v_mov_b32 v188, 0xbdd2d3e8
    v_mov_b32 v190, 0xc0135761
    v_mov_b32 v189, 0xbdd2d3e8
    v_mov_b32 v191, 0xc0135761
    s_waitcnt lgkmcnt(0)
    v_lshlrev_b32 v72, 16, v142
    v_and_b32 v73, 0xffff0000, v142
    v_lshlrev_b32 v74, 16, v143
    v_and_b32 v75, 0xffff0000, v143
    v_lshlrev_b32 v76, 16, v144
    v_and_b32 v77, 0xffff0000, v144
    v_lshlrev_b32 v78, 16, v145
    v_and_b32 v79, 0xffff0000, v145
    v_lshlrev_b32 v80, 16, v146
    v_and_b32 v81, 0xffff0000, v146
    v_lshlrev_b32 v82, 16, v147
    v_and_b32 v83, 0xffff0000, v147
    v_lshlrev_b32 v84, 16, v148
    v_and_b32 v85, 0xffff0000, v148
    v_lshlrev_b32 v86, 16, v149
    v_and_b32 v87, 0xffff0000, v149
    v_lshlrev_b32 v88, 16, v150
    v_and_b32 v89, 0xffff0000, v150
    v_lshlrev_b32 v90, 16, v151
    v_and_b32 v91, 0xffff0000, v151
    v_lshlrev_b32 v92, 16, v152
    v_and_b32 v93, 0xffff0000, v152
    v_lshlrev_b32 v94, 16, v153
    v_and_b32 v95, 0xffff0000, v153
    v_lshlrev_b32 v96, 16, v154
    v_and_b32 v97, 0xffff0000, v154
    v_lshlrev_b32 v98, 16, v155
    v_and_b32 v99, 0xffff0000, v155
    v_lshlrev_b32 v100, 16, v156
    v_and_b32 v101, 0xffff0000, v156
    v_lshlrev_b32 v102, 16, v157
    v_and_b32 v103, 0xffff0000, v157
    v_lshlrev_b32 v104, 16, v158
    v_and_b32 v105, 0xffff0000, v158
    v_lshlrev_b32 v106, 16, v159
    v_and_b32 v107, 0xffff0000, v159
    v_lshlrev_b32 v108, 16, v160
    v_and_b32 v109, 0xffff0000, v160
    v_lshlrev_b32 v110, 16, v161
    v_and_b32 v111, 0xffff0000, v161
    v_lshlrev_b32 v112, 16, v162
    v_and_b32 v113, 0xffff0000, v162
    v_lshlrev_b32 v114, 16, v163
    v_and_b32 v115, 0xffff0000, v163
    v_lshlrev_b32 v116, 16, v164
    v_and_b32 v117, 0xffff0000, v164
    v_lshlrev_b32 v118, 16, v165
    v_and_b32 v119, 0xffff0000, v165
    v_lshlrev_b32 v120, 16, v166
    v_and_b32 v121, 0xffff0000, v166
    v_lshlrev_b32 v122, 16, v167
    v_and_b32 v123, 0xffff0000, v167
    v_lshlrev_b32 v124, 16, v168
    v_and_b32 v125, 0xffff0000, v168
    v_lshlrev_b32 v126, 16, v169
    v_and_b32 v127, 0xffff0000, v169
    s_mov_b32 exec_hi, s91
    v_lshlrev_b32 v13, 1, v56
    v_subrev_u32 v13, s89, v13
    v_cmp_le_u32 s[60:61], s90, v13
    s_mov_b64 exec, -1
L_fb0:
    s_cmp_eq_u64 s[60:61], 0
    s_cbranch_scc1 L_fbn0
    s_ff1_i32_b64 s55, s[60:61]
    s_bitset0_b64 s[60:61], s55
    v_readlane_b32 s48, v56, s55
    s_nop 4
    s_call_b64 s[62:63], L_mlp
    v_readfirstlane_b32 s49, v13
    s_mov_b32 m0, s55
    s_nop 0
    v_writelane_b32 v40, s49, m0
    s_branch L_fb0
L_fbn0:
    s_mov_b32 exec_hi, s91
    v_lshlrev_b32 v13, 1, v57
    v_subrev_u32 v13, s89, v13
    v_cmp_le_u32 s[60:61], s90, v13
    s_mov_b64 exec, -1
L_fb1:
    s_cmp_eq_u64 s[60:61], 0
    s_cbranch_scc1 L_fbn1
    s_ff1_i32_b64 s55, s[60:61]
    s_bitset0_b64 s[60:61], s55
    v_readlane_b32 s48, v57, s55
    s_nop 4
    s_call_b64 s[62:63], L_mlp
    v_readfirstlane_b32 s49, v13
    s_mov_b32 m0, s55
    s_nop 0
    v_writelane_b32 v41, s49, m0
    s_branch L_fb1
L_fbn1:
    s_mov_b32 exec_hi, s91
    s_branch L_nofb
.section .rodata,"a"
.p2align 6
.amdhsa_kernel sequential_preLN__mha_block_cached__mixer_token_mlp__decode_kernel
  .amdhsa_next_free_vgpr 208
  .amdhsa_next_free_sgpr 102
  .amdhsa_accum_offset 208
  .amdhsa_group_segment_fixed_size 0
  .amdhsa_kernarg_size 104
  .amdhsa_user_sgpr_count 2
  .amdhsa_user_sgpr_kernarg_segment_ptr 1
  .amdhsa_system_sgpr_workgroup_id_x 1
  .amdhsa_float_denorm_mode_32 3
.end_amdhsa_kernel
```
